```python
import torch

def _softmax(x, axis=-1):
    return torch.softmax(x, dim=axis)
def _gelu(x):
    return torch.nn.functional.gelu(x, approximate="tanh")
def _silu(x):
    return torch.nn.functional.silu(x)
def _sigmoid(x):
    return torch.sigmoid(x)
def _layernorm(x, axis=-1, eps=1e-5):
    m = x.mean(dim=axis, keepdim=True)
    v = x.var(dim=axis, keepdim=True, unbiased=False)
    return (x - m) / torch.sqrt(v + eps)
def _scatter_add(tgt, idx, src, axis=0):
    return tgt.clone().index_add_(axis, idx, src)
def _segment_sum(src, seg, n):
    out = torch.zeros((n,) + src.shape[1:], dtype=src.dtype)
    return out.index_add_(0, seg, src)
def _pad(x, pw):
    flat = tuple(v for pair in reversed(pw) for v in pair)
    return torch.nn.functional.pad(x, flat)

kernel_name = 'standalone__fused_io_aware_attn__prompt'

def setup_inputs():

    _w = (lambda a: (lambda t: t.to(torch.bfloat16) if t.is_floating_point() else t)(torch.as_tensor(a)))
    B, H, S = 1, 32, 2048
    Dh = max(1, 640 // 32)
    return {
        "q": _w((lambda *s: torch.randn(*s, dtype=torch.bfloat16) * 0.8)(B, H, S, Dh)),
        "k": _w((lambda *s: torch.randn(*s, dtype=torch.bfloat16) * 0.8)(B, H, S, Dh)),
        "v": _w((lambda *s: torch.randn(*s, dtype=torch.bfloat16) * 0.05)(B, H, S, Dh)),
    }

def reference(q, k, v):
    scale = q.shape[-1] ** -0.5
    s = torch.einsum('bhqd,bhkd->bhqk', q, k) * scale
    p = _softmax(s, axis=-1)
    return torch.einsum('bhqk,bhkd->bhqd', p, v)
```

```asm
; @launch grid=(256,1,1) block=(576,1,1) lds=163840
.amdgcn_target "amdgcn-amd-amdhsa--gfx950"
.text
.globl standalone__fused_io_aware_attn__prompt_kernel
.p2align 8
.type standalone__fused_io_aware_attn__prompt_kernel,@function
standalone__fused_io_aware_attn__prompt_kernel:
    s_load_dwordx2 s[8:9], s[0:1], 0
    s_load_dwordx2 s[12:13], s[0:1], 8
    s_load_dwordx2 s[16:17], s[0:1], 16
    s_load_dwordx2 s[20:21], s[0:1], 24
    s_cmp_ge_u32 s2, 256
    s_cbranch_scc1 L_end
    s_getpc_b64 s[6:7]
    v_mul_u32_u24 v4, 20, v0
    global_load_dword v124, v4, s[6:7]
    v_lshrrev_b32 v3, 6, v0
    v_and_b32 v0, 63, v0
    v_readfirstlane_b32 s24, v3
    v_lshlrev_b32 v6, 4, v0
    v_lshlrev_b32 v5, 2, v0
    s_and_b32 s3, s2, 7
    s_lshr_b32 s4, s2, 6
    s_lshl_b32 s4, s4, 3
    s_add_u32 s3, s3, s4
    s_mul_i32 s3, s3, 81920
    s_bfe_u32 s4, s2, 0x30003
    s_mul_i32 s4, s4, 10240
    s_add_u32 s4, s4, s3
    s_mul_i32 s33, s24, 1280
    s_add_u32 s35, s4, s33
    s_and_b32 s32, s24, 1
    s_cselect_b32 s5, 0, 79872
    s_cselect_b32 s7, 2048, 0
    s_addk_i32 s5, 4096
    s_lshr_b32 s6, s24, 1
    s_lshl_b32 s38, s6, 11
    s_add_u32 m0, s5, s38
    s_lshl_b32 s39, s6, 10
    s_add_u32 s5, s5, s7
    s_add_u32 s5, s5, s39
    s_add_u32 s5, s5, 38912
    s_add_u32 s39, s39, 40960
    s_add_u32 s38, s38, s3
    s_add_u32 s39, s39, s3
    s_mov_b32 s14, 2621440
    s_mov_b32 s15, 0x20000
    s_mov_b64 s[30:31], s[14:15]
    s_mov_b64 s[10:11], s[14:15]
    s_mov_b64 s[18:19], s[14:15]
    s_cmp_eq_u32 s24, 8
    s_cbranch_scc1 L_loader
    s_cmp_eq_u32 s32, 1
    s_waitcnt lgkmcnt(0)
    buffer_load_dwordx4 v[92:95], v6, s[8:11], s35 offen
    buffer_load_dword v96, v5, s[8:11], s35 offen offset:1024
    s_cselect_b32 s28, s16, s12
    s_cselect_b32 s29, s17, s13
    buffer_load_dwordx4 v6, s[28:31], s38 offen lds
    buffer_load_dwordx4 v6, s[28:31], s38 offen offset:1024 lds
    s_mov_b32 m0, s5
    s_lshr_b32 s26, s24, 2
    buffer_load_dwordx4 v6, s[28:31], s39 offen lds
    s_add_u32 s33, s33, 73728
    v_add_u32 v47, s33, v6
    v_add_u32 v48, s33, v5
    s_mov_b32 s8, 0x3ea52b5c
    s_mov_b32 s9, s8
    v_mov_b64 v[118:119], 0
    s_mov_b64 s[22:23], s[14:15]
    s_and_b32 s25, s24, 3
    s_mov_b32 s34, 0
    v_mfma_f32_32x32x4_2b_bf16 v[52:83], v[118:119], v[118:119], 0
    v_and_b32 v3, 31, v0
    v_lshrrev_b32 v4, 5, v0
    v_mul_u32_u24 v5, 40, v3
    v_lshl_add_u32 v7, v4, 4, v5
    s_mul_i32 s5, s25, 2560
    s_mul_i32 s6, s26, 1280
    s_add_u32 s7, s5, s6
    s_add_u32 s27, s4, s7
    s_add_u32 s7, s7, 73728
    v_add_u32 v45, s7, v7
    s_sub_u32 s7, s5, s6
    s_add_u32 s7, s7, 75008
    v_add_u32 v44, s7, v7
    v_xor_b32 v18, s26, v4
    v_xor_b32 v18, 1, v18
    v_mul_u32_u24 v18, 0x500, v18
    s_add_u32 s5, s5, 73760
    v_add3_u32 v46, v18, v5, s5
    s_mul_i32 s5, s26, 38912
    s_add_u32 s5, s5, 83968
    v_add_u32 v2, s5, v7
    v_mov_b32 v26, v2
    s_mov_b32 exec_hi, 0
    v_mov_b32 v26, 0x40000
    s_mov_b64 exec, -1
    v_bfe_u32 v3, v0, 2, 2
    v_lshl_add_u32 v3, v4, 3, v3
    v_mul_u32_u24 v3, 40, v3
    v_and_b32 v5, 1, v0
    v_lshl_add_u32 v3, v5, 4, v3
    v_bfe_u32 v5, v0, 1, 1
    v_lshl_add_u32 v3, v5, 3, v3
    v_bfe_u32 v5, v0, 4, 1
    v_lshl_add_u32 v3, v5, 5, v3
    s_mul_i32 s5, s26, 40960
    s_addk_i32 s5, 4096
    v_add_u32 v3, s5, v3
    v_and_b32 v5, 19, v0
    v_cmp_lt_u32 vcc, 16, v5
    v_cmp_eq_u32 s[6:7], 17, v5
    v_mov_b32 v120, 0x40000
    v_mov_b32 v121, 224
    v_cndmask_b32 v120, v120, v121, s[6:7]
    v_mov_b32 v121, 3840
    v_cndmask_b32 v148, v3, v120, vcc
    v_cndmask_b32 v121, v121, 0, vcc
    v_mov_b32 v1, 0xdddddddd
    v_add_u32 v149, v148, v121
    v_add_u32 v150, v149, v121
    v_add_u32 v151, v150, v121
    v_add_u32 v152, v151, v121
    v_add_u32 v153, v152, v121
    v_add_u32 v154, v153, v121
    v_add_u32 v155, v154, v121
    v_add_u32 v156, v155, v121
    v_add_u32 v157, v156, v121
    v_add_u32 v158, v157, v121
    s_lshl_b32 s5, s26, 1
    s_sub_u32 s5, 1, s5
    s_mul_i32 s6, s5, 38912
    s_mul_i32 s7, s5, 40960
    v_add_u32 v34, s6, v2
    v_mul_u32_u24 v27, 1264, v4
    v_add3_u32 v27, v27, v2, 32
    v_add_u32 v35, s6, v27
    v_mov_b32 v18, s7
    v_cndmask_b32 v18, v18, 0, vcc
    v_add_u32 v18, v18, v158
    s_mul_i32 s5, s25, 3072
    s_add_u32 s6, s5, 86016
    s_add_u32 s7, s5, 4096
    s_cmp_eq_u32 s26, 1
    s_cselect_b32 s38, s6, s7
    s_cselect_b32 s39, s7, s6
    s_waitcnt vmcnt(3)
    v_lshlrev_b32 v100, 16, v92
    v_and_b32 v101, 0xffff0000, v92
    v_lshlrev_b32 v102, 16, v93
    v_and_b32 v103, 0xffff0000, v93
    v_lshlrev_b32 v104, 16, v94
    v_and_b32 v105, 0xffff0000, v94
    v_lshlrev_b32 v106, 16, v95
    v_and_b32 v107, 0xffff0000, v95
    v_lshlrev_b32 v108, 16, v96
    v_and_b32 v109, 0xffff0000, v96
    v_pk_mul_f32 v[100:101], v[100:101], s[8:9]
    v_pk_mul_f32 v[102:103], v[102:103], s[8:9]
    v_pk_mul_f32 v[104:105], v[104:105], s[8:9]
    v_pk_mul_f32 v[106:107], v[106:107], s[8:9]
    v_pk_mul_f32 v[108:109], v[108:109], s[8:9]
    v_cvt_pk_bf16_f32 v92, v100, v101
    v_cvt_pk_bf16_f32 v93, v102, v103
    v_cvt_pk_bf16_f32 v94, v104, v105
    v_cvt_pk_bf16_f32 v95, v106, v107
    v_cvt_pk_bf16_f32 v96, v108, v109
    ds_write_b128 v47, v[92:95]
    ds_write_b32 v48, v96 offset:1024
    s_setprio 3
    s_waitcnt vmcnt(0) lgkmcnt(0)
    s_barrier
    ds_read_b64 v[24:25], v26 offset:16
    ds_read_b64 v[16:17], v46
    ds_read_b64 v[20:21], v2
    ds_read_b64 v[22:23], v2 offset:8
    ds_read_b64 v[8:9], v44
    ds_read_b64 v[10:11], v44 offset:8
    ds_read_b64 v[12:13], v45
    ds_read_b64 v[14:15], v45 offset:8
    s_waitcnt lgkmcnt(6)
    v_mfma_f32_32x32x4_2b_bf16 v[84:115], v[24:25], v[16:17], 4.0 cbsz:1 abid:1
    ds_read_b64 v[28:29], v2 offset:1280
    ds_read_b64 v[30:31], v2 offset:1288
    ds_read_b64 v[32:33], v26 offset:1296
    ds_read_b64_tr_b16 v[36:37], v148 offset:0
    ds_read_b64_tr_b16 v[38:39], v148 offset:160
    ds_read_b64_tr_b16 v[40:41], v148 offset:640
    ds_read_b64_tr_b16 v[42:43], v148 offset:800
    s_nop 9
    s_waitcnt lgkmcnt(7)
    v_mfma_f32_32x32x16_bf16 v[84:99], v[20:23], v[8:11], v[84:99]
    s_nop 10
L_loop:
    v_mfma_f32_32x32x16_bf16 v[100:115], v[20:23], v[12:15], v[100:115]
    v_exp_f32 v84, v84
    v_exp_f32 v85, v85
    v_exp_f32 v86, v86
    v_exp_f32 v87, v87
    v_exp_f32 v88, v88
    v_exp_f32 v89, v89
    s_waitcnt lgkmcnt(0)
    ds_read_b64 v[20:21], v2 offset:2560
    ds_read_b64 v[22:23], v2 offset:2568
    ds_read_b64 v[24:25], v26 offset:2576
    ds_read_b64_tr_b16 v[44:45], v148 offset:1280
    ds_read_b64_tr_b16 v[46:47], v148 offset:1440
    ds_read_b64_tr_b16 v[48:49], v148 offset:1920
    ds_read_b64_tr_b16 v[50:51], v148 offset:2080
    v_exp_f32 v90, v90
    v_exp_f32 v91, v91
    v_exp_f32 v92, v92
    v_exp_f32 v93, v93
    v_exp_f32 v94, v94
    v_exp_f32 v95, v95
    v_mfma_f32_32x32x4_2b_bf16 v[116:147], v[32:33], v[16:17], 4.0 cbsz:1 abid:1
    v_exp_f32 v96, v96
    v_exp_f32 v97, v97
    v_exp_f32 v98, v98
    v_exp_f32 v99, v99
    v_exp_f32 v100, v100
    v_exp_f32 v101, v101
    v_exp_f32 v102, v102
    v_exp_f32 v103, v103
    v_smfmac_f32_32x32x32_bf16 v[52:67], v[36:39], v[84:91], v1
    v_exp_f32 v104, v104
    v_exp_f32 v105, v105
    v_exp_f32 v106, v106
    v_smfmac_f32_32x32x32_bf16 v[52:67], v[40:43], v[92:99], v1
    v_exp_f32 v107, v107
    v_exp_f32 v108, v108
    v_exp_f32 v109, v109
    v_mfma_f32_32x32x16_bf16 v[116:131], v[28:31], v[8:11], v[116:131]
    v_exp_f32 v110, v110
    v_exp_f32 v111, v111
    v_exp_f32 v112, v112
    v_smfmac_f32_32x32x32_bf16 v[68:83], v[36:39], v[100:107], v1
    s_cbranch_scc0 L_nb0
    s_barrier
L_nb0:
    v_exp_f32 v113, v113
    v_exp_f32 v114, v114
    v_exp_f32 v115, v115
    v_mfma_f32_32x32x16_bf16 v[132:147], v[28:31], v[12:15], v[132:147]
    v_exp_f32 v116, v116
    v_exp_f32 v117, v117
    v_exp_f32 v118, v118
    v_smfmac_f32_32x32x32_bf16 v[68:83], v[40:43], v[108:115], v1
    v_exp_f32 v119, v119
    v_exp_f32 v120, v120
    v_exp_f32 v121, v121
    s_waitcnt lgkmcnt(0)
    ds_read_b64 v[28:29], v2 offset:3840
    ds_read_b64 v[30:31], v2 offset:3848
    ds_read_b64 v[32:33], v26 offset:3856
    ds_read_b64_tr_b16 v[36:37], v148 offset:2560
    ds_read_b64_tr_b16 v[38:39], v148 offset:2720
    ds_read_b64_tr_b16 v[40:41], v148 offset:3200
    ds_read_b64_tr_b16 v[42:43], v148 offset:3360
    v_exp_f32 v122, v122
    v_exp_f32 v123, v123
    v_exp_f32 v124, v124
    v_exp_f32 v125, v125
    v_exp_f32 v126, v126
    v_exp_f32 v127, v127
    v_mfma_f32_32x32x4_2b_bf16 v[84:115], v[24:25], v[16:17], 4.0 cbsz:1 abid:1
    v_exp_f32 v128, v128
    v_exp_f32 v129, v129
    v_exp_f32 v130, v130
    v_exp_f32 v131, v131
    v_exp_f32 v132, v132
    v_exp_f32 v133, v133
    v_exp_f32 v134, v134
    v_exp_f32 v135, v135
    v_smfmac_f32_32x32x32_bf16 v[52:67], v[44:47], v[116:123], v1
    v_exp_f32 v136, v136
    v_exp_f32 v137, v137
    v_exp_f32 v138, v138
    v_smfmac_f32_32x32x32_bf16 v[52:67], v[48:51], v[124:131], v1
    v_exp_f32 v139, v139
    v_exp_f32 v140, v140
    v_exp_f32 v141, v141
    v_mfma_f32_32x32x16_bf16 v[84:99], v[20:23], v[8:11], v[84:99]
    v_exp_f32 v142, v142
    v_exp_f32 v143, v143
    v_exp_f32 v144, v144
    v_smfmac_f32_32x32x32_bf16 v[68:83], v[44:47], v[132:139], v1
    v_exp_f32 v145, v145
    v_exp_f32 v146, v146
    v_exp_f32 v147, v147
    v_mfma_f32_32x32x16_bf16 v[100:115], v[20:23], v[12:15], v[100:115]
    v_exp_f32 v84, v84
    v_exp_f32 v85, v85
    v_exp_f32 v86, v86
    v_smfmac_f32_32x32x32_bf16 v[68:83], v[48:51], v[140:147], v1
    v_exp_f32 v87, v87
    v_exp_f32 v88, v88
    v_exp_f32 v89, v89
    s_waitcnt lgkmcnt(0)
    ds_read_b64 v[20:21], v2 offset:5120
    ds_read_b64 v[22:23], v2 offset:5128
    ds_read_b64 v[24:25], v26 offset:5136
    ds_read_b64_tr_b16 v[44:45], v149 offset:0
    ds_read_b64_tr_b16 v[46:47], v149 offset:160
    ds_read_b64_tr_b16 v[48:49], v149 offset:640
    ds_read_b64_tr_b16 v[50:51], v149 offset:800
    v_exp_f32 v90, v90
    v_exp_f32 v91, v91
    v_exp_f32 v92, v92
    v_exp_f32 v93, v93
    v_exp_f32 v94, v94
    v_exp_f32 v95, v95
    v_mfma_f32_32x32x4_2b_bf16 v[116:147], v[32:33], v[16:17], 4.0 cbsz:1 abid:1
    v_exp_f32 v96, v96
    v_exp_f32 v97, v97
    v_exp_f32 v98, v98
    v_exp_f32 v99, v99
    v_exp_f32 v100, v100
    v_exp_f32 v101, v101
    v_exp_f32 v102, v102
    v_exp_f32 v103, v103
    v_smfmac_f32_32x32x32_bf16 v[52:67], v[36:39], v[84:91], v1
    v_exp_f32 v104, v104
    v_exp_f32 v105, v105
    v_exp_f32 v106, v106
    v_smfmac_f32_32x32x32_bf16 v[52:67], v[40:43], v[92:99], v1
    v_exp_f32 v107, v107
    v_exp_f32 v108, v108
    v_exp_f32 v109, v109
    v_mfma_f32_32x32x16_bf16 v[116:131], v[28:31], v[8:11], v[116:131]
    v_exp_f32 v110, v110
    v_exp_f32 v111, v111
    v_exp_f32 v112, v112
    v_smfmac_f32_32x32x32_bf16 v[68:83], v[36:39], v[100:107], v1
    s_cbranch_scc0 L_nb1
    s_barrier
L_nb1:
    v_exp_f32 v113, v113
    v_exp_f32 v114, v114
    v_exp_f32 v115, v115
    v_mfma_f32_32x32x16_bf16 v[132:147], v[28:31], v[12:15], v[132:147]
    v_exp_f32 v116, v116
    v_exp_f32 v117, v117
    v_exp_f32 v118, v118
    v_smfmac_f32_32x32x32_bf16 v[68:83], v[40:43], v[108:115], v1
    v_exp_f32 v119, v119
    v_exp_f32 v120, v120
    v_exp_f32 v121, v121
    s_waitcnt lgkmcnt(0)
    ds_read_b64 v[28:29], v2 offset:6400
    ds_read_b64 v[30:31], v2 offset:6408
    ds_read_b64 v[32:33], v26 offset:6416
    ds_read_b64_tr_b16 v[36:37], v149 offset:1280
    ds_read_b64_tr_b16 v[38:39], v149 offset:1440
    ds_read_b64_tr_b16 v[40:41], v149 offset:1920
    ds_read_b64_tr_b16 v[42:43], v149 offset:2080
    v_exp_f32 v122, v122
    v_exp_f32 v123, v123
    v_exp_f32 v124, v124
    v_exp_f32 v125, v125
    v_exp_f32 v126, v126
    v_exp_f32 v127, v127
    v_mfma_f32_32x32x4_2b_bf16 v[84:115], v[24:25], v[16:17], 4.0 cbsz:1 abid:1
    v_exp_f32 v128, v128
    v_exp_f32 v129, v129
    v_exp_f32 v130, v130
    v_exp_f32 v131, v131
    v_exp_f32 v132, v132
    v_exp_f32 v133, v133
    v_exp_f32 v134, v134
    v_exp_f32 v135, v135
    v_smfmac_f32_32x32x32_bf16 v[52:67], v[44:47], v[116:123], v1
    v_exp_f32 v136, v136
    v_exp_f32 v137, v137
    v_exp_f32 v138, v138
    v_smfmac_f32_32x32x32_bf16 v[52:67], v[48:51], v[124:131], v1
    v_exp_f32 v139, v139
    v_exp_f32 v140, v140
    v_exp_f32 v141, v141
    v_mfma_f32_32x32x16_bf16 v[84:99], v[20:23], v[8:11], v[84:99]
    v_exp_f32 v142, v142
    v_exp_f32 v143, v143
    v_exp_f32 v144, v144
    v_smfmac_f32_32x32x32_bf16 v[68:83], v[44:47], v[132:139], v1
    v_exp_f32 v145, v145
    v_exp_f32 v146, v146
    v_exp_f32 v147, v147
    v_mfma_f32_32x32x16_bf16 v[100:115], v[20:23], v[12:15], v[100:115]
    v_exp_f32 v84, v84
    v_exp_f32 v85, v85
    v_exp_f32 v86, v86
    v_smfmac_f32_32x32x32_bf16 v[68:83], v[48:51], v[140:147], v1
    v_exp_f32 v87, v87
    v_exp_f32 v88, v88
    v_exp_f32 v89, v89
    s_waitcnt lgkmcnt(0)
    s_cbranch_scc1 L_na0
    s_barrier
L_na0:
    ds_read_b64 v[20:21], v2 offset:7680
    ds_read_b64 v[22:23], v2 offset:7688
    ds_read_b64 v[24:25], v26 offset:7696
    ds_read_b64_tr_b16 v[44:45], v149 offset:2560
    ds_read_b64_tr_b16 v[46:47], v149 offset:2720
    ds_read_b64_tr_b16 v[48:49], v149 offset:3200
    ds_read_b64_tr_b16 v[50:51], v149 offset:3360
    v_exp_f32 v90, v90
    v_exp_f32 v91, v91
    v_exp_f32 v92, v92
    v_exp_f32 v93, v93
    v_exp_f32 v94, v94
    v_exp_f32 v95, v95
    v_mfma_f32_32x32x4_2b_bf16 v[116:147], v[32:33], v[16:17], 4.0 cbsz:1 abid:1
    v_exp_f32 v96, v96
    v_exp_f32 v97, v97
    v_exp_f32 v98, v98
    v_exp_f32 v99, v99
    v_exp_f32 v100, v100
    v_exp_f32 v101, v101
    v_exp_f32 v102, v102
    v_exp_f32 v103, v103
    v_smfmac_f32_32x32x32_bf16 v[52:67], v[36:39], v[84:91], v1
    v_exp_f32 v104, v104
    v_exp_f32 v105, v105
    v_exp_f32 v106, v106
    v_smfmac_f32_32x32x32_bf16 v[52:67], v[40:43], v[92:99], v1
    v_exp_f32 v107, v107
    v_exp_f32 v108, v108
    v_exp_f32 v109, v109
    v_mfma_f32_32x32x16_bf16 v[116:131], v[28:31], v[8:11], v[116:131]
    v_exp_f32 v110, v110
    v_exp_f32 v111, v111
    v_exp_f32 v112, v112
    v_smfmac_f32_32x32x32_bf16 v[68:83], v[36:39], v[100:107], v1
    v_exp_f32 v113, v113
    v_exp_f32 v114, v114
    v_exp_f32 v115, v115
    v_mfma_f32_32x32x16_bf16 v[132:147], v[28:31], v[12:15], v[132:147]
    v_exp_f32 v116, v116
    v_exp_f32 v117, v117
    v_exp_f32 v118, v118
    v_smfmac_f32_32x32x32_bf16 v[68:83], v[40:43], v[108:115], v1
    v_exp_f32 v119, v119
    v_exp_f32 v120, v120
    v_exp_f32 v121, v121
    s_waitcnt lgkmcnt(0)
    ds_read_b64 v[28:29], v2 offset:8960
    ds_read_b64 v[30:31], v2 offset:8968
    ds_read_b64 v[32:33], v26 offset:8976
    ds_read_b64_tr_b16 v[36:37], v150 offset:0
    ds_read_b64_tr_b16 v[38:39], v150 offset:160
    ds_read_b64_tr_b16 v[40:41], v150 offset:640
    ds_read_b64_tr_b16 v[42:43], v150 offset:800
    v_exp_f32 v122, v122
    v_exp_f32 v123, v123
    v_exp_f32 v124, v124
    v_exp_f32 v125, v125
    v_exp_f32 v126, v126
    v_exp_f32 v127, v127
    v_mfma_f32_32x32x4_2b_bf16 v[84:115], v[24:25], v[16:17], 4.0 cbsz:1 abid:1
    v_exp_f32 v128, v128
    v_exp_f32 v129, v129
    v_exp_f32 v130, v130
    v_exp_f32 v131, v131
    v_exp_f32 v132, v132
    v_exp_f32 v133, v133
    v_exp_f32 v134, v134
    v_exp_f32 v135, v135
    v_smfmac_f32_32x32x32_bf16 v[52:67], v[44:47], v[116:123], v1
    v_exp_f32 v136, v136
    v_exp_f32 v137, v137
    v_exp_f32 v138, v138
    v_smfmac_f32_32x32x32_bf16 v[52:67], v[48:51], v[124:131], v1
    v_exp_f32 v139, v139
    v_exp_f32 v140, v140
    v_exp_f32 v141, v141
    v_mfma_f32_32x32x16_bf16 v[84:99], v[20:23], v[8:11], v[84:99]
    v_exp_f32 v142, v142
    v_exp_f32 v143, v143
    v_exp_f32 v144, v144
    v_smfmac_f32_32x32x32_bf16 v[68:83], v[44:47], v[132:139], v1
    v_exp_f32 v145, v145
    v_exp_f32 v146, v146
    v_exp_f32 v147, v147
    v_mfma_f32_32x32x16_bf16 v[100:115], v[20:23], v[12:15], v[100:115]
    v_exp_f32 v84, v84
    v_exp_f32 v85, v85
    v_exp_f32 v86, v86
    v_smfmac_f32_32x32x32_bf16 v[68:83], v[48:51], v[140:147], v1
    v_exp_f32 v87, v87
    v_exp_f32 v88, v88
    v_exp_f32 v89, v89
    s_waitcnt lgkmcnt(0)
    ds_read_b64 v[20:21], v2 offset:10240
    ds_read_b64 v[22:23], v2 offset:10248
    ds_read_b64 v[24:25], v26 offset:10256
    ds_read_b64_tr_b16 v[44:45], v150 offset:1280
    ds_read_b64_tr_b16 v[46:47], v150 offset:1440
    ds_read_b64_tr_b16 v[48:49], v150 offset:1920
    ds_read_b64_tr_b16 v[50:51], v150 offset:2080
    v_exp_f32 v90, v90
    v_exp_f32 v91, v91
    v_exp_f32 v92, v92
    v_exp_f32 v93, v93
    v_exp_f32 v94, v94
    v_exp_f32 v95, v95
    v_mfma_f32_32x32x4_2b_bf16 v[116:147], v[32:33], v[16:17], 4.0 cbsz:1 abid:1
    v_exp_f32 v96, v96
    v_exp_f32 v97, v97
    v_exp_f32 v98, v98
    v_exp_f32 v99, v99
    v_exp_f32 v100, v100
    v_exp_f32 v101, v101
    v_exp_f32 v102, v102
    v_exp_f32 v103, v103
    v_smfmac_f32_32x32x32_bf16 v[52:67], v[36:39], v[84:91], v1
    v_exp_f32 v104, v104
    v_exp_f32 v105, v105
    v_exp_f32 v106, v106
    v_smfmac_f32_32x32x32_bf16 v[52:67], v[40:43], v[92:99], v1
    v_exp_f32 v107, v107
    v_exp_f32 v108, v108
    v_exp_f32 v109, v109
    v_mfma_f32_32x32x16_bf16 v[116:131], v[28:31], v[8:11], v[116:131]
    v_exp_f32 v110, v110
    v_exp_f32 v111, v111
    v_exp_f32 v112, v112
    v_smfmac_f32_32x32x32_bf16 v[68:83], v[36:39], v[100:107], v1
    v_exp_f32 v113, v113
    v_exp_f32 v114, v114
    v_exp_f32 v115, v115
    v_mfma_f32_32x32x16_bf16 v[132:147], v[28:31], v[12:15], v[132:147]
    v_exp_f32 v116, v116
    v_exp_f32 v117, v117
    v_exp_f32 v118, v118
    v_smfmac_f32_32x32x32_bf16 v[68:83], v[40:43], v[108:115], v1
    v_exp_f32 v119, v119
    v_exp_f32 v120, v120
    v_exp_f32 v121, v121
    s_waitcnt lgkmcnt(0)
    ds_read_b64 v[28:29], v2 offset:11520
    ds_read_b64 v[30:31], v2 offset:11528
    ds_read_b64 v[32:33], v26 offset:11536
    ds_read_b64_tr_b16 v[36:37], v150 offset:2560
    ds_read_b64_tr_b16 v[38:39], v150 offset:2720
    ds_read_b64_tr_b16 v[40:41], v150 offset:3200
    ds_read_b64_tr_b16 v[42:43], v150 offset:3360
    v_exp_f32 v122, v122
    v_exp_f32 v123, v123
    v_exp_f32 v124, v124
    v_exp_f32 v125, v125
    v_exp_f32 v126, v126
    v_exp_f32 v127, v127
    v_mfma_f32_32x32x4_2b_bf16 v[84:115], v[24:25], v[16:17], 4.0 cbsz:1 abid:1
    v_exp_f32 v128, v128
    v_exp_f32 v129, v129
    v_exp_f32 v130, v130
    v_exp_f32 v131, v131
    v_exp_f32 v132, v132
    v_exp_f32 v133, v133
    v_exp_f32 v134, v134
    v_exp_f32 v135, v135
    v_smfmac_f32_32x32x32_bf16 v[52:67], v[44:47], v[116:123], v1
    v_exp_f32 v136, v136
    v_exp_f32 v137, v137
    v_exp_f32 v138, v138
    v_smfmac_f32_32x32x32_bf16 v[52:67], v[48:51], v[124:131], v1
    v_exp_f32 v139, v139
    v_exp_f32 v140, v140
    v_exp_f32 v141, v141
    v_mfma_f32_32x32x16_bf16 v[84:99], v[20:23], v[8:11], v[84:99]
    v_exp_f32 v142, v142
    v_exp_f32 v143, v143
    v_exp_f32 v144, v144
    v_smfmac_f32_32x32x32_bf16 v[68:83], v[44:47], v[132:139], v1
    v_exp_f32 v145, v145
    v_exp_f32 v146, v146
    v_exp_f32 v147, v147
    v_mfma_f32_32x32x16_bf16 v[100:115], v[20:23], v[12:15], v[100:115]
    v_exp_f32 v84, v84
    v_exp_f32 v85, v85
    v_exp_f32 v86, v86
    v_smfmac_f32_32x32x32_bf16 v[68:83], v[48:51], v[140:147], v1
    v_exp_f32 v87, v87
    v_exp_f32 v88, v88
    v_exp_f32 v89, v89
    s_waitcnt lgkmcnt(0)
    ds_read_b64 v[20:21], v2 offset:12800
    ds_read_b64 v[22:23], v2 offset:12808
    ds_read_b64 v[24:25], v26 offset:12816
    ds_read_b64_tr_b16 v[44:45], v151 offset:0
    ds_read_b64_tr_b16 v[46:47], v151 offset:160
    ds_read_b64_tr_b16 v[48:49], v151 offset:640
    ds_read_b64_tr_b16 v[50:51], v151 offset:800
    v_exp_f32 v90, v90
    v_exp_f32 v91, v91
    v_exp_f32 v92, v92
    v_exp_f32 v93, v93
    v_exp_f32 v94, v94
    v_exp_f32 v95, v95
    v_mfma_f32_32x32x4_2b_bf16 v[116:147], v[32:33], v[16:17], 4.0 cbsz:1 abid:1
    v_exp_f32 v96, v96
    v_exp_f32 v97, v97
    v_exp_f32 v98, v98
    v_exp_f32 v99, v99
    v_exp_f32 v100, v100
    v_exp_f32 v101, v101
    v_exp_f32 v102, v102
    v_exp_f32 v103, v103
    v_smfmac_f32_32x32x32_bf16 v[52:67], v[36:39], v[84:91], v1
    v_exp_f32 v104, v104
    v_exp_f32 v105, v105
    v_exp_f32 v106, v106
    v_smfmac_f32_32x32x32_bf16 v[52:67], v[40:43], v[92:99], v1
    v_exp_f32 v107, v107
    v_exp_f32 v108, v108
    v_exp_f32 v109, v109
    v_mfma_f32_32x32x16_bf16 v[116:131], v[28:31], v[8:11], v[116:131]
    v_exp_f32 v110, v110
    v_exp_f32 v111, v111
    v_exp_f32 v112, v112
    v_smfmac_f32_32x32x32_bf16 v[68:83], v[36:39], v[100:107], v1
    v_exp_f32 v113, v113
    v_exp_f32 v114, v114
    v_exp_f32 v115, v115
    v_mfma_f32_32x32x16_bf16 v[132:147], v[28:31], v[12:15], v[132:147]
    v_exp_f32 v116, v116
    v_exp_f32 v117, v117
    v_exp_f32 v118, v118
    v_smfmac_f32_32x32x32_bf16 v[68:83], v[40:43], v[108:115], v1
    v_exp_f32 v119, v119
    v_exp_f32 v120, v120
    v_exp_f32 v121, v121
    s_waitcnt lgkmcnt(0)
    ds_read_b64 v[28:29], v2 offset:14080
    ds_read_b64 v[30:31], v2 offset:14088
    ds_read_b64 v[32:33], v26 offset:14096
    ds_read_b64_tr_b16 v[36:37], v151 offset:1280
    ds_read_b64_tr_b16 v[38:39], v151 offset:1440
    ds_read_b64_tr_b16 v[40:41], v151 offset:1920
    ds_read_b64_tr_b16 v[42:43], v151 offset:2080
    v_exp_f32 v122, v122
    v_exp_f32 v123, v123
    v_exp_f32 v124, v124
    v_exp_f32 v125, v125
    v_exp_f32 v126, v126
    v_exp_f32 v127, v127
    v_mfma_f32_32x32x4_2b_bf16 v[84:115], v[24:25], v[16:17], 4.0 cbsz:1 abid:1
    v_exp_f32 v128, v128
    v_exp_f32 v129, v129
    v_exp_f32 v130, v130
    v_exp_f32 v131, v131
    v_exp_f32 v132, v132
    v_exp_f32 v133, v133
    v_exp_f32 v134, v134
    v_exp_f32 v135, v135
    v_smfmac_f32_32x32x32_bf16 v[52:67], v[44:47], v[116:123], v1
    v_exp_f32 v136, v136
    v_exp_f32 v137, v137
    v_exp_f32 v138, v138
    v_smfmac_f32_32x32x32_bf16 v[52:67], v[48:51], v[124:131], v1
    v_exp_f32 v139, v139
    v_exp_f32 v140, v140
    v_exp_f32 v141, v141
    v_mfma_f32_32x32x16_bf16 v[84:99], v[20:23], v[8:11], v[84:99]
    v_exp_f32 v142, v142
    v_exp_f32 v143, v143
    v_exp_f32 v144, v144
    v_smfmac_f32_32x32x32_bf16 v[68:83], v[44:47], v[132:139], v1
    v_exp_f32 v145, v145
    v_exp_f32 v146, v146
    v_exp_f32 v147, v147
    v_mfma_f32_32x32x16_bf16 v[100:115], v[20:23], v[12:15], v[100:115]
    v_exp_f32 v84, v84
    v_exp_f32 v85, v85
    v_exp_f32 v86, v86
    v_smfmac_f32_32x32x32_bf16 v[68:83], v[48:51], v[140:147], v1
    v_exp_f32 v87, v87
    v_exp_f32 v88, v88
    v_exp_f32 v89, v89
    s_waitcnt lgkmcnt(0)
    ds_read_b64 v[20:21], v2 offset:15360
    ds_read_b64 v[22:23], v2 offset:15368
    ds_read_b64 v[24:25], v26 offset:15376
    ds_read_b64_tr_b16 v[44:45], v151 offset:2560
    ds_read_b64_tr_b16 v[46:47], v151 offset:2720
    ds_read_b64_tr_b16 v[48:49], v151 offset:3200
    ds_read_b64_tr_b16 v[50:51], v151 offset:3360
    v_exp_f32 v90, v90
    v_exp_f32 v91, v91
    v_exp_f32 v92, v92
    v_exp_f32 v93, v93
    v_exp_f32 v94, v94
    v_exp_f32 v95, v95
    v_mfma_f32_32x32x4_2b_bf16 v[116:147], v[32:33], v[16:17], 4.0 cbsz:1 abid:1
    v_exp_f32 v96, v96
    v_exp_f32 v97, v97
    v_exp_f32 v98, v98
    v_exp_f32 v99, v99
    v_exp_f32 v100, v100
    v_exp_f32 v101, v101
    v_exp_f32 v102, v102
    v_exp_f32 v103, v103
    v_smfmac_f32_32x32x32_bf16 v[52:67], v[36:39], v[84:91], v1
    v_exp_f32 v104, v104
    v_exp_f32 v105, v105
    v_exp_f32 v106, v106
    v_smfmac_f32_32x32x32_bf16 v[52:67], v[40:43], v[92:99], v1
    v_exp_f32 v107, v107
    v_exp_f32 v108, v108
    v_exp_f32 v109, v109
    v_mfma_f32_32x32x16_bf16 v[116:131], v[28:31], v[8:11], v[116:131]
    v_exp_f32 v110, v110
    v_exp_f32 v111, v111
    v_exp_f32 v112, v112
    v_smfmac_f32_32x32x32_bf16 v[68:83], v[36:39], v[100:107], v1
    v_exp_f32 v113, v113
    v_exp_f32 v114, v114
    v_exp_f32 v115, v115
    v_mfma_f32_32x32x16_bf16 v[132:147], v[28:31], v[12:15], v[132:147]
    v_exp_f32 v116, v116
    v_exp_f32 v117, v117
    v_exp_f32 v118, v118
    v_smfmac_f32_32x32x32_bf16 v[68:83], v[40:43], v[108:115], v1
    v_exp_f32 v119, v119
    v_exp_f32 v120, v120
    v_exp_f32 v121, v121
    s_waitcnt lgkmcnt(0)
    ds_read_b64 v[28:29], v2 offset:16640
    ds_read_b64 v[30:31], v2 offset:16648
    ds_read_b64 v[32:33], v26 offset:16656
    ds_read_b64_tr_b16 v[36:37], v152 offset:0
    ds_read_b64_tr_b16 v[38:39], v152 offset:160
    ds_read_b64_tr_b16 v[40:41], v152 offset:640
    ds_read_b64_tr_b16 v[42:43], v152 offset:800
    v_exp_f32 v122, v122
    v_exp_f32 v123, v123
    v_exp_f32 v124, v124
    v_exp_f32 v125, v125
    v_exp_f32 v126, v126
    v_exp_f32 v127, v127
    v_mfma_f32_32x32x4_2b_bf16 v[84:115], v[24:25], v[16:17], 4.0 cbsz:1 abid:1
    v_exp_f32 v128, v128
    v_exp_f32 v129, v129
    v_exp_f32 v130, v130
    v_exp_f32 v131, v131
    v_exp_f32 v132, v132
    v_exp_f32 v133, v133
    v_exp_f32 v134, v134
    v_exp_f32 v135, v135
    v_smfmac_f32_32x32x32_bf16 v[52:67], v[44:47], v[116:123], v1
    v_exp_f32 v136, v136
    v_exp_f32 v137, v137
    v_exp_f32 v138, v138
    v_smfmac_f32_32x32x32_bf16 v[52:67], v[48:51], v[124:131], v1
    v_exp_f32 v139, v139
    v_exp_f32 v140, v140
    v_exp_f32 v141, v141
    v_mfma_f32_32x32x16_bf16 v[84:99], v[20:23], v[8:11], v[84:99]
    v_exp_f32 v142, v142
    v_exp_f32 v143, v143
    v_exp_f32 v144, v144
    v_smfmac_f32_32x32x32_bf16 v[68:83], v[44:47], v[132:139], v1
    v_exp_f32 v145, v145
    v_exp_f32 v146, v146
    v_exp_f32 v147, v147
    v_mfma_f32_32x32x16_bf16 v[100:115], v[20:23], v[12:15], v[100:115]
    v_exp_f32 v84, v84
    v_exp_f32 v85, v85
    v_exp_f32 v86, v86
    v_smfmac_f32_32x32x32_bf16 v[68:83], v[48:51], v[140:147], v1
    v_exp_f32 v87, v87
    v_exp_f32 v88, v88
    v_exp_f32 v89, v89
    s_waitcnt lgkmcnt(0)
    ds_read_b64 v[20:21], v2 offset:17920
    ds_read_b64 v[22:23], v2 offset:17928
    ds_read_b64 v[24:25], v26 offset:17936
    ds_read_b64_tr_b16 v[44:45], v152 offset:1280
    ds_read_b64_tr_b16 v[46:47], v152 offset:1440
    ds_read_b64_tr_b16 v[48:49], v152 offset:1920
    ds_read_b64_tr_b16 v[50:51], v152 offset:2080
    v_exp_f32 v90, v90
    v_exp_f32 v91, v91
    v_exp_f32 v92, v92
    v_exp_f32 v93, v93
    v_exp_f32 v94, v94
    v_exp_f32 v95, v95
    v_mfma_f32_32x32x4_2b_bf16 v[116:147], v[32:33], v[16:17], 4.0 cbsz:1 abid:1
    v_exp_f32 v96, v96
    v_exp_f32 v97, v97
    v_exp_f32 v98, v98
    v_exp_f32 v99, v99
    v_exp_f32 v100, v100
    v_exp_f32 v101, v101
    v_exp_f32 v102, v102
    v_exp_f32 v103, v103
    v_smfmac_f32_32x32x32_bf16 v[52:67], v[36:39], v[84:91], v1
    v_exp_f32 v104, v104
    v_exp_f32 v105, v105
    v_exp_f32 v106, v106
    v_smfmac_f32_32x32x32_bf16 v[52:67], v[40:43], v[92:99], v1
    v_exp_f32 v107, v107
    v_exp_f32 v108, v108
    v_exp_f32 v109, v109
    v_mfma_f32_32x32x16_bf16 v[116:131], v[28:31], v[8:11], v[116:131]
    v_exp_f32 v110, v110
    v_exp_f32 v111, v111
    v_exp_f32 v112, v112
    v_smfmac_f32_32x32x32_bf16 v[68:83], v[36:39], v[100:107], v1
    v_exp_f32 v113, v113
    v_exp_f32 v114, v114
    v_exp_f32 v115, v115
    v_mfma_f32_32x32x16_bf16 v[132:147], v[28:31], v[12:15], v[132:147]
    v_exp_f32 v116, v116
    v_exp_f32 v117, v117
    v_exp_f32 v118, v118
    v_smfmac_f32_32x32x32_bf16 v[68:83], v[40:43], v[108:115], v1
    v_exp_f32 v119, v119
    v_exp_f32 v120, v120
    v_exp_f32 v121, v121
    s_waitcnt lgkmcnt(0)
    ds_read_b64 v[28:29], v2 offset:19200
    ds_read_b64 v[30:31], v2 offset:19208
    ds_read_b64 v[32:33], v26 offset:19216
    ds_read_b64_tr_b16 v[36:37], v152 offset:2560
    ds_read_b64_tr_b16 v[38:39], v152 offset:2720
    ds_read_b64_tr_b16 v[40:41], v152 offset:3200
    ds_read_b64_tr_b16 v[42:43], v152 offset:3360
    v_exp_f32 v122, v122
    v_exp_f32 v123, v123
    v_exp_f32 v124, v124
    v_exp_f32 v125, v125
    v_exp_f32 v126, v126
    v_exp_f32 v127, v127
    v_mfma_f32_32x32x4_2b_bf16 v[84:115], v[24:25], v[16:17], 4.0 cbsz:1 abid:1
    v_exp_f32 v128, v128
    v_exp_f32 v129, v129
    v_exp_f32 v130, v130
    v_exp_f32 v131, v131
    v_exp_f32 v132, v132
    v_exp_f32 v133, v133
    v_exp_f32 v134, v134
    v_exp_f32 v135, v135
    v_smfmac_f32_32x32x32_bf16 v[52:67], v[44:47], v[116:123], v1
    v_exp_f32 v136, v136
    v_exp_f32 v137, v137
    v_exp_f32 v138, v138
    v_smfmac_f32_32x32x32_bf16 v[52:67], v[48:51], v[124:131], v1
    v_exp_f32 v139, v139
    v_exp_f32 v140, v140
    v_exp_f32 v141, v141
    v_mfma_f32_32x32x16_bf16 v[84:99], v[20:23], v[8:11], v[84:99]
    v_exp_f32 v142, v142
    v_exp_f32 v143, v143
    v_exp_f32 v144, v144
    v_smfmac_f32_32x32x32_bf16 v[68:83], v[44:47], v[132:139], v1
    v_exp_f32 v145, v145
    v_exp_f32 v146, v146
    v_exp_f32 v147, v147
    v_mfma_f32_32x32x16_bf16 v[100:115], v[20:23], v[12:15], v[100:115]
    v_exp_f32 v84, v84
    v_exp_f32 v85, v85
    v_exp_f32 v86, v86
    v_smfmac_f32_32x32x32_bf16 v[68:83], v[48:51], v[140:147], v1
    v_exp_f32 v87, v87
    v_exp_f32 v88, v88
    v_exp_f32 v89, v89
    s_waitcnt lgkmcnt(0)
    s_cbranch_scc1 L_na1
    s_barrier
L_na1:
    ds_read_b64 v[20:21], v2 offset:20480
    ds_read_b64 v[22:23], v2 offset:20488
    ds_read_b64 v[24:25], v26 offset:20496
    ds_read_b64_tr_b16 v[44:45], v153 offset:0
    ds_read_b64_tr_b16 v[46:47], v153 offset:160
    ds_read_b64_tr_b16 v[48:49], v153 offset:640
    ds_read_b64_tr_b16 v[50:51], v153 offset:800
    v_exp_f32 v90, v90
    v_exp_f32 v91, v91
    v_exp_f32 v92, v92
    v_exp_f32 v93, v93
    v_exp_f32 v94, v94
    v_exp_f32 v95, v95
    v_mfma_f32_32x32x4_2b_bf16 v[116:147], v[32:33], v[16:17], 4.0 cbsz:1 abid:1
    v_exp_f32 v96, v96
    v_exp_f32 v97, v97
    v_exp_f32 v98, v98
    v_exp_f32 v99, v99
    v_exp_f32 v100, v100
    v_exp_f32 v101, v101
    v_exp_f32 v102, v102
    v_exp_f32 v103, v103
    v_smfmac_f32_32x32x32_bf16 v[52:67], v[36:39], v[84:91], v1
    v_exp_f32 v104, v104
    v_exp_f32 v105, v105
    v_exp_f32 v106, v106
    v_smfmac_f32_32x32x32_bf16 v[52:67], v[40:43], v[92:99], v1
    v_exp_f32 v107, v107
    v_exp_f32 v108, v108
    v_exp_f32 v109, v109
    v_mfma_f32_32x32x16_bf16 v[116:131], v[28:31], v[8:11], v[116:131]
    v_exp_f32 v110, v110
    v_exp_f32 v111, v111
    v_exp_f32 v112, v112
    v_smfmac_f32_32x32x32_bf16 v[68:83], v[36:39], v[100:107], v1
    v_exp_f32 v113, v113
    v_exp_f32 v114, v114
    v_exp_f32 v115, v115
    v_mfma_f32_32x32x16_bf16 v[132:147], v[28:31], v[12:15], v[132:147]
    v_exp_f32 v116, v116
    v_exp_f32 v117, v117
    v_exp_f32 v118, v118
    v_smfmac_f32_32x32x32_bf16 v[68:83], v[40:43], v[108:115], v1
    v_exp_f32 v119, v119
    v_exp_f32 v120, v120
    v_exp_f32 v121, v121
    s_waitcnt lgkmcnt(0)
    ds_read_b64 v[28:29], v2 offset:21760
    ds_read_b64 v[30:31], v2 offset:21768
    ds_read_b64 v[32:33], v26 offset:21776
    ds_read_b64_tr_b16 v[36:37], v153 offset:1280
    ds_read_b64_tr_b16 v[38:39], v153 offset:1440
    ds_read_b64_tr_b16 v[40:41], v153 offset:1920
    ds_read_b64_tr_b16 v[42:43], v153 offset:2080
    v_exp_f32 v122, v122
    v_exp_f32 v123, v123
    v_exp_f32 v124, v124
    v_exp_f32 v125, v125
    v_exp_f32 v126, v126
    v_exp_f32 v127, v127
    v_mfma_f32_32x32x4_2b_bf16 v[84:115], v[24:25], v[16:17], 4.0 cbsz:1 abid:1
    v_exp_f32 v128, v128
    v_exp_f32 v129, v129
    v_exp_f32 v130, v130
    v_exp_f32 v131, v131
    v_exp_f32 v132, v132
    v_exp_f32 v133, v133
    v_exp_f32 v134, v134
    v_exp_f32 v135, v135
    v_smfmac_f32_32x32x32_bf16 v[52:67], v[44:47], v[116:123], v1
    v_exp_f32 v136, v136
    v_exp_f32 v137, v137
    v_exp_f32 v138, v138
    v_smfmac_f32_32x32x32_bf16 v[52:67], v[48:51], v[124:131], v1
    v_exp_f32 v139, v139
    v_exp_f32 v140, v140
    v_exp_f32 v141, v141
    v_mfma_f32_32x32x16_bf16 v[84:99], v[20:23], v[8:11], v[84:99]
    v_exp_f32 v142, v142
    v_exp_f32 v143, v143
    v_exp_f32 v144, v144
    v_smfmac_f32_32x32x32_bf16 v[68:83], v[44:47], v[132:139], v1
    v_exp_f32 v145, v145
    v_exp_f32 v146, v146
    v_exp_f32 v147, v147
    v_mfma_f32_32x32x16_bf16 v[100:115], v[20:23], v[12:15], v[100:115]
    v_exp_f32 v84, v84
    v_exp_f32 v85, v85
    v_exp_f32 v86, v86
    v_smfmac_f32_32x32x32_bf16 v[68:83], v[48:51], v[140:147], v1
    v_exp_f32 v87, v87
    v_exp_f32 v88, v88
    v_exp_f32 v89, v89
    s_waitcnt lgkmcnt(0)
    ds_read_b64 v[20:21], v2 offset:23040
    ds_read_b64 v[22:23], v2 offset:23048
    ds_read_b64 v[24:25], v26 offset:23056
    ds_read_b64_tr_b16 v[44:45], v153 offset:2560
    ds_read_b64_tr_b16 v[46:47], v153 offset:2720
    ds_read_b64_tr_b16 v[48:49], v153 offset:3200
    ds_read_b64_tr_b16 v[50:51], v153 offset:3360
    v_exp_f32 v90, v90
    v_exp_f32 v91, v91
    v_exp_f32 v92, v92
    v_exp_f32 v93, v93
    v_exp_f32 v94, v94
    v_exp_f32 v95, v95
    v_mfma_f32_32x32x4_2b_bf16 v[116:147], v[32:33], v[16:17], 4.0 cbsz:1 abid:1
    v_exp_f32 v96, v96
    v_exp_f32 v97, v97
    v_exp_f32 v98, v98
    v_exp_f32 v99, v99
    v_exp_f32 v100, v100
    v_exp_f32 v101, v101
    v_exp_f32 v102, v102
    v_exp_f32 v103, v103
    v_smfmac_f32_32x32x32_bf16 v[52:67], v[36:39], v[84:91], v1
    v_exp_f32 v104, v104
    v_exp_f32 v105, v105
    v_exp_f32 v106, v106
    v_smfmac_f32_32x32x32_bf16 v[52:67], v[40:43], v[92:99], v1
    v_exp_f32 v107, v107
    v_exp_f32 v108, v108
    v_exp_f32 v109, v109
    v_mfma_f32_32x32x16_bf16 v[116:131], v[28:31], v[8:11], v[116:131]
    v_exp_f32 v110, v110
    v_exp_f32 v111, v111
    v_exp_f32 v112, v112
    v_smfmac_f32_32x32x32_bf16 v[68:83], v[36:39], v[100:107], v1
    v_exp_f32 v113, v113
    v_exp_f32 v114, v114
    v_exp_f32 v115, v115
    v_mfma_f32_32x32x16_bf16 v[132:147], v[28:31], v[12:15], v[132:147]
    v_exp_f32 v116, v116
    v_exp_f32 v117, v117
    v_exp_f32 v118, v118
    v_smfmac_f32_32x32x32_bf16 v[68:83], v[40:43], v[108:115], v1
    v_exp_f32 v119, v119
    v_exp_f32 v120, v120
    v_exp_f32 v121, v121
    s_waitcnt lgkmcnt(0)
    ds_read_b64 v[28:29], v2 offset:24320
    ds_read_b64 v[30:31], v2 offset:24328
    ds_read_b64 v[32:33], v26 offset:24336
    ds_read_b64_tr_b16 v[36:37], v154 offset:0
    ds_read_b64_tr_b16 v[38:39], v154 offset:160
    ds_read_b64_tr_b16 v[40:41], v154 offset:640
    ds_read_b64_tr_b16 v[42:43], v154 offset:800
    v_exp_f32 v122, v122
    v_exp_f32 v123, v123
    v_exp_f32 v124, v124
    v_exp_f32 v125, v125
    v_exp_f32 v126, v126
    v_exp_f32 v127, v127
    v_mfma_f32_32x32x4_2b_bf16 v[84:115], v[24:25], v[16:17], 4.0 cbsz:1 abid:1
    v_exp_f32 v128, v128
    v_exp_f32 v129, v129
    v_exp_f32 v130, v130
    v_exp_f32 v131, v131
    v_exp_f32 v132, v132
    v_exp_f32 v133, v133
    v_exp_f32 v134, v134
    v_exp_f32 v135, v135
    v_smfmac_f32_32x32x32_bf16 v[52:67], v[44:47], v[116:123], v1
    v_exp_f32 v136, v136
    v_exp_f32 v137, v137
    v_exp_f32 v138, v138
    v_smfmac_f32_32x32x32_bf16 v[52:67], v[48:51], v[124:131], v1
    v_exp_f32 v139, v139
    v_exp_f32 v140, v140
    v_exp_f32 v141, v141
    v_mfma_f32_32x32x16_bf16 v[84:99], v[20:23], v[8:11], v[84:99]
    v_exp_f32 v142, v142
    v_exp_f32 v143, v143
    v_exp_f32 v144, v144
    v_smfmac_f32_32x32x32_bf16 v[68:83], v[44:47], v[132:139], v1
    v_exp_f32 v145, v145
    v_exp_f32 v146, v146
    v_exp_f32 v147, v147
    v_mfma_f32_32x32x16_bf16 v[100:115], v[20:23], v[12:15], v[100:115]
    v_exp_f32 v84, v84
    v_exp_f32 v85, v85
    v_exp_f32 v86, v86
    v_smfmac_f32_32x32x32_bf16 v[68:83], v[48:51], v[140:147], v1
    v_exp_f32 v87, v87
    v_exp_f32 v88, v88
    v_exp_f32 v89, v89
    s_waitcnt lgkmcnt(0)
    ds_read_b64 v[20:21], v2 offset:25600
    ds_read_b64 v[22:23], v2 offset:25608
    ds_read_b64 v[24:25], v26 offset:25616
    ds_read_b64_tr_b16 v[44:45], v154 offset:1280
    ds_read_b64_tr_b16 v[46:47], v154 offset:1440
    ds_read_b64_tr_b16 v[48:49], v154 offset:1920
    ds_read_b64_tr_b16 v[50:51], v154 offset:2080
    v_exp_f32 v90, v90
    v_exp_f32 v91, v91
    v_exp_f32 v92, v92
    v_exp_f32 v93, v93
    v_exp_f32 v94, v94
    v_exp_f32 v95, v95
    v_mfma_f32_32x32x4_2b_bf16 v[116:147], v[32:33], v[16:17], 4.0 cbsz:1 abid:1
    v_exp_f32 v96, v96
    v_exp_f32 v97, v97
    v_exp_f32 v98, v98
    v_exp_f32 v99, v99
    v_exp_f32 v100, v100
    v_exp_f32 v101, v101
    v_exp_f32 v102, v102
    v_exp_f32 v103, v103
    v_smfmac_f32_32x32x32_bf16 v[52:67], v[36:39], v[84:91], v1
    v_exp_f32 v104, v104
    v_exp_f32 v105, v105
    v_exp_f32 v106, v106
    v_smfmac_f32_32x32x32_bf16 v[52:67], v[40:43], v[92:99], v1
    v_exp_f32 v107, v107
    v_exp_f32 v108, v108
    v_exp_f32 v109, v109
    v_mfma_f32_32x32x16_bf16 v[116:131], v[28:31], v[8:11], v[116:131]
    v_exp_f32 v110, v110
    v_exp_f32 v111, v111
    v_exp_f32 v112, v112
    v_smfmac_f32_32x32x32_bf16 v[68:83], v[36:39], v[100:107], v1
    v_exp_f32 v113, v113
    v_exp_f32 v114, v114
    v_exp_f32 v115, v115
    v_mfma_f32_32x32x16_bf16 v[132:147], v[28:31], v[12:15], v[132:147]
    v_exp_f32 v116, v116
    v_exp_f32 v117, v117
    v_exp_f32 v118, v118
    v_smfmac_f32_32x32x32_bf16 v[68:83], v[40:43], v[108:115], v1
    v_exp_f32 v119, v119
    v_exp_f32 v120, v120
    v_exp_f32 v121, v121
    s_waitcnt lgkmcnt(0)
    ds_read_b64 v[28:29], v2 offset:26880
    ds_read_b64 v[30:31], v2 offset:26888
    ds_read_b64 v[32:33], v26 offset:26896
    ds_read_b64_tr_b16 v[36:37], v154 offset:2560
    ds_read_b64_tr_b16 v[38:39], v154 offset:2720
    ds_read_b64_tr_b16 v[40:41], v154 offset:3200
    ds_read_b64_tr_b16 v[42:43], v154 offset:3360
    v_exp_f32 v122, v122
    v_exp_f32 v123, v123
    v_exp_f32 v124, v124
    v_exp_f32 v125, v125
    v_exp_f32 v126, v126
    v_exp_f32 v127, v127
    v_mfma_f32_32x32x4_2b_bf16 v[84:115], v[24:25], v[16:17], 4.0 cbsz:1 abid:1
    v_exp_f32 v128, v128
    v_exp_f32 v129, v129
    v_exp_f32 v130, v130
    v_exp_f32 v131, v131
    v_exp_f32 v132, v132
    v_exp_f32 v133, v133
    v_exp_f32 v134, v134
    v_exp_f32 v135, v135
    v_smfmac_f32_32x32x32_bf16 v[52:67], v[44:47], v[116:123], v1
    v_exp_f32 v136, v136
    v_exp_f32 v137, v137
    v_exp_f32 v138, v138
    v_smfmac_f32_32x32x32_bf16 v[52:67], v[48:51], v[124:131], v1
    v_exp_f32 v139, v139
    v_exp_f32 v140, v140
    v_exp_f32 v141, v141
    v_mfma_f32_32x32x16_bf16 v[84:99], v[20:23], v[8:11], v[84:99]
    v_exp_f32 v142, v142
    v_exp_f32 v143, v143
    v_exp_f32 v144, v144
    v_smfmac_f32_32x32x32_bf16 v[68:83], v[44:47], v[132:139], v1
    v_exp_f32 v145, v145
    v_exp_f32 v146, v146
    v_exp_f32 v147, v147
    v_mfma_f32_32x32x16_bf16 v[100:115], v[20:23], v[12:15], v[100:115]
    v_exp_f32 v84, v84
    v_exp_f32 v85, v85
    v_exp_f32 v86, v86
    v_smfmac_f32_32x32x32_bf16 v[68:83], v[48:51], v[140:147], v1
    v_exp_f32 v87, v87
    v_exp_f32 v88, v88
    v_exp_f32 v89, v89
    s_waitcnt lgkmcnt(0)
    ds_read_b64 v[20:21], v2 offset:28160
    ds_read_b64 v[22:23], v2 offset:28168
    ds_read_b64 v[24:25], v26 offset:28176
    ds_read_b64_tr_b16 v[44:45], v155 offset:0
    ds_read_b64_tr_b16 v[46:47], v155 offset:160
    ds_read_b64_tr_b16 v[48:49], v155 offset:640
    ds_read_b64_tr_b16 v[50:51], v155 offset:800
    v_exp_f32 v90, v90
    v_exp_f32 v91, v91
    v_exp_f32 v92, v92
    v_exp_f32 v93, v93
    v_exp_f32 v94, v94
    v_exp_f32 v95, v95
    v_mfma_f32_32x32x4_2b_bf16 v[116:147], v[32:33], v[16:17], 4.0 cbsz:1 abid:1
    v_exp_f32 v96, v96
    v_exp_f32 v97, v97
    v_exp_f32 v98, v98
    v_exp_f32 v99, v99
    v_exp_f32 v100, v100
    v_exp_f32 v101, v101
    v_exp_f32 v102, v102
    v_exp_f32 v103, v103
    v_smfmac_f32_32x32x32_bf16 v[52:67], v[36:39], v[84:91], v1
    v_exp_f32 v104, v104
    v_exp_f32 v105, v105
    v_exp_f32 v106, v106
    v_smfmac_f32_32x32x32_bf16 v[52:67], v[40:43], v[92:99], v1
    v_exp_f32 v107, v107
    v_exp_f32 v108, v108
    v_exp_f32 v109, v109
    v_mfma_f32_32x32x16_bf16 v[116:131], v[28:31], v[8:11], v[116:131]
    v_exp_f32 v110, v110
    v_exp_f32 v111, v111
    v_exp_f32 v112, v112
    v_smfmac_f32_32x32x32_bf16 v[68:83], v[36:39], v[100:107], v1
    v_exp_f32 v113, v113
    v_exp_f32 v114, v114
    v_exp_f32 v115, v115
    v_mfma_f32_32x32x16_bf16 v[132:147], v[28:31], v[12:15], v[132:147]
    v_exp_f32 v116, v116
    v_exp_f32 v117, v117
    v_exp_f32 v118, v118
    v_smfmac_f32_32x32x32_bf16 v[68:83], v[40:43], v[108:115], v1
    v_exp_f32 v119, v119
    v_exp_f32 v120, v120
    v_exp_f32 v121, v121
    s_waitcnt lgkmcnt(0)
    ds_read_b64 v[28:29], v2 offset:29440
    ds_read_b64 v[30:31], v2 offset:29448
    ds_read_b64 v[32:33], v26 offset:29456
    ds_read_b64_tr_b16 v[36:37], v155 offset:1280
    ds_read_b64_tr_b16 v[38:39], v155 offset:1440
    ds_read_b64_tr_b16 v[40:41], v155 offset:1920
    ds_read_b64_tr_b16 v[42:43], v155 offset:2080
    v_exp_f32 v122, v122
    v_exp_f32 v123, v123
    v_exp_f32 v124, v124
    v_exp_f32 v125, v125
    v_exp_f32 v126, v126
    v_exp_f32 v127, v127
    v_mfma_f32_32x32x4_2b_bf16 v[84:115], v[24:25], v[16:17], 4.0 cbsz:1 abid:1
    v_exp_f32 v128, v128
    v_exp_f32 v129, v129
    v_exp_f32 v130, v130
    v_exp_f32 v131, v131
    v_exp_f32 v132, v132
    v_exp_f32 v133, v133
    v_exp_f32 v134, v134
    v_exp_f32 v135, v135
    v_smfmac_f32_32x32x32_bf16 v[52:67], v[44:47], v[116:123], v1
    v_exp_f32 v136, v136
    v_exp_f32 v137, v137
    v_exp_f32 v138, v138
    v_smfmac_f32_32x32x32_bf16 v[52:67], v[48:51], v[124:131], v1
    v_exp_f32 v139, v139
    v_exp_f32 v140, v140
    v_exp_f32 v141, v141
    v_mfma_f32_32x32x16_bf16 v[84:99], v[20:23], v[8:11], v[84:99]
    v_exp_f32 v142, v142
    v_exp_f32 v143, v143
    v_exp_f32 v144, v144
    v_smfmac_f32_32x32x32_bf16 v[68:83], v[44:47], v[132:139], v1
    v_exp_f32 v145, v145
    v_exp_f32 v146, v146
    v_exp_f32 v147, v147
    v_mfma_f32_32x32x16_bf16 v[100:115], v[20:23], v[12:15], v[100:115]
    v_exp_f32 v84, v84
    v_exp_f32 v85, v85
    v_exp_f32 v86, v86
    v_smfmac_f32_32x32x32_bf16 v[68:83], v[48:51], v[140:147], v1
    v_exp_f32 v87, v87
    v_exp_f32 v88, v88
    v_exp_f32 v89, v89
    s_waitcnt lgkmcnt(0)
    ds_read_b64 v[20:21], v2 offset:30720
    ds_read_b64 v[22:23], v2 offset:30728
    ds_read_b64 v[24:25], v26 offset:30736
    ds_read_b64_tr_b16 v[44:45], v155 offset:2560
    ds_read_b64_tr_b16 v[46:47], v155 offset:2720
    ds_read_b64_tr_b16 v[48:49], v155 offset:3200
    ds_read_b64_tr_b16 v[50:51], v155 offset:3360
    v_exp_f32 v90, v90
    v_exp_f32 v91, v91
    v_exp_f32 v92, v92
    v_exp_f32 v93, v93
    v_exp_f32 v94, v94
    v_exp_f32 v95, v95
    v_mfma_f32_32x32x4_2b_bf16 v[116:147], v[32:33], v[16:17], 4.0 cbsz:1 abid:1
    v_exp_f32 v96, v96
    v_exp_f32 v97, v97
    v_exp_f32 v98, v98
    v_exp_f32 v99, v99
    v_exp_f32 v100, v100
    v_exp_f32 v101, v101
    v_exp_f32 v102, v102
    v_exp_f32 v103, v103
    v_smfmac_f32_32x32x32_bf16 v[52:67], v[36:39], v[84:91], v1
    v_exp_f32 v104, v104
    v_exp_f32 v105, v105
    v_exp_f32 v106, v106
    v_smfmac_f32_32x32x32_bf16 v[52:67], v[40:43], v[92:99], v1
    v_exp_f32 v107, v107
    v_exp_f32 v108, v108
    v_exp_f32 v109, v109
    v_mfma_f32_32x32x16_bf16 v[116:131], v[28:31], v[8:11], v[116:131]
    v_exp_f32 v110, v110
    v_exp_f32 v111, v111
    v_exp_f32 v112, v112
    v_smfmac_f32_32x32x32_bf16 v[68:83], v[36:39], v[100:107], v1
    v_exp_f32 v113, v113
    v_exp_f32 v114, v114
    v_exp_f32 v115, v115
    v_mfma_f32_32x32x16_bf16 v[132:147], v[28:31], v[12:15], v[132:147]
    v_exp_f32 v116, v116
    v_exp_f32 v117, v117
    v_exp_f32 v118, v118
    v_smfmac_f32_32x32x32_bf16 v[68:83], v[40:43], v[108:115], v1
    v_exp_f32 v119, v119
    v_exp_f32 v120, v120
    v_exp_f32 v121, v121
    s_waitcnt lgkmcnt(0)
    ds_read_b64 v[28:29], v2 offset:32000
    ds_read_b64 v[30:31], v2 offset:32008
    ds_read_b64 v[32:33], v26 offset:32016
    ds_read_b64_tr_b16 v[36:37], v156 offset:0
    ds_read_b64_tr_b16 v[38:39], v156 offset:160
    ds_read_b64_tr_b16 v[40:41], v156 offset:640
    ds_read_b64_tr_b16 v[42:43], v156 offset:800
    v_exp_f32 v122, v122
    v_exp_f32 v123, v123
    v_exp_f32 v124, v124
    v_exp_f32 v125, v125
    v_exp_f32 v126, v126
    v_exp_f32 v127, v127
    v_mfma_f32_32x32x4_2b_bf16 v[84:115], v[24:25], v[16:17], 4.0 cbsz:1 abid:1
    v_exp_f32 v128, v128
    v_exp_f32 v129, v129
    v_exp_f32 v130, v130
    v_exp_f32 v131, v131
    v_exp_f32 v132, v132
    v_exp_f32 v133, v133
    v_exp_f32 v134, v134
    v_exp_f32 v135, v135
    v_smfmac_f32_32x32x32_bf16 v[52:67], v[44:47], v[116:123], v1
    v_exp_f32 v136, v136
    v_exp_f32 v137, v137
    v_exp_f32 v138, v138
    v_smfmac_f32_32x32x32_bf16 v[52:67], v[48:51], v[124:131], v1
    v_exp_f32 v139, v139
    v_exp_f32 v140, v140
    v_exp_f32 v141, v141
    v_mfma_f32_32x32x16_bf16 v[84:99], v[20:23], v[8:11], v[84:99]
    v_exp_f32 v142, v142
    v_exp_f32 v143, v143
    v_exp_f32 v144, v144
    v_smfmac_f32_32x32x32_bf16 v[68:83], v[44:47], v[132:139], v1
    v_exp_f32 v145, v145
    v_exp_f32 v146, v146
    v_exp_f32 v147, v147
    v_mfma_f32_32x32x16_bf16 v[100:115], v[20:23], v[12:15], v[100:115]
    v_exp_f32 v84, v84
    v_exp_f32 v85, v85
    v_exp_f32 v86, v86
    v_smfmac_f32_32x32x32_bf16 v[68:83], v[48:51], v[140:147], v1
    v_exp_f32 v87, v87
    v_exp_f32 v88, v88
    v_exp_f32 v89, v89
    s_waitcnt lgkmcnt(0)
    ds_read_b64 v[20:21], v2 offset:33280
    ds_read_b64 v[22:23], v2 offset:33288
    ds_read_b64 v[24:25], v26 offset:33296
    ds_read_b64_tr_b16 v[44:45], v156 offset:1280
    ds_read_b64_tr_b16 v[46:47], v156 offset:1440
    ds_read_b64_tr_b16 v[48:49], v156 offset:1920
    ds_read_b64_tr_b16 v[50:51], v156 offset:2080
    v_exp_f32 v90, v90
    v_exp_f32 v91, v91
    v_exp_f32 v92, v92
    v_exp_f32 v93, v93
    v_exp_f32 v94, v94
    v_exp_f32 v95, v95
    v_mfma_f32_32x32x4_2b_bf16 v[116:147], v[32:33], v[16:17], 4.0 cbsz:1 abid:1
    v_exp_f32 v96, v96
    v_exp_f32 v97, v97
    v_exp_f32 v98, v98
    v_exp_f32 v99, v99
    v_exp_f32 v100, v100
    v_exp_f32 v101, v101
    v_exp_f32 v102, v102
    v_exp_f32 v103, v103
    v_smfmac_f32_32x32x32_bf16 v[52:67], v[36:39], v[84:91], v1
    v_exp_f32 v104, v104
    v_exp_f32 v105, v105
    v_exp_f32 v106, v106
    v_smfmac_f32_32x32x32_bf16 v[52:67], v[40:43], v[92:99], v1
    v_exp_f32 v107, v107
    v_exp_f32 v108, v108
    v_exp_f32 v109, v109
    v_mfma_f32_32x32x16_bf16 v[116:131], v[28:31], v[8:11], v[116:131]
    v_exp_f32 v110, v110
    v_exp_f32 v111, v111
    v_exp_f32 v112, v112
    v_smfmac_f32_32x32x32_bf16 v[68:83], v[36:39], v[100:107], v1
    v_exp_f32 v113, v113
    v_exp_f32 v114, v114
    v_exp_f32 v115, v115
    v_mfma_f32_32x32x16_bf16 v[132:147], v[28:31], v[12:15], v[132:147]
    v_exp_f32 v116, v116
    v_exp_f32 v117, v117
    v_exp_f32 v118, v118
    v_smfmac_f32_32x32x32_bf16 v[68:83], v[40:43], v[108:115], v1
    v_exp_f32 v119, v119
    v_exp_f32 v120, v120
    v_exp_f32 v121, v121
    s_waitcnt lgkmcnt(0)
    ds_read_b64 v[28:29], v2 offset:34560
    ds_read_b64 v[30:31], v2 offset:34568
    ds_read_b64 v[32:33], v26 offset:34576
    ds_read_b64_tr_b16 v[36:37], v156 offset:2560
    ds_read_b64_tr_b16 v[38:39], v156 offset:2720
    ds_read_b64_tr_b16 v[40:41], v156 offset:3200
    ds_read_b64_tr_b16 v[42:43], v156 offset:3360
    v_exp_f32 v122, v122
    v_exp_f32 v123, v123
    v_exp_f32 v124, v124
    v_exp_f32 v125, v125
    v_exp_f32 v126, v126
    v_exp_f32 v127, v127
    v_mfma_f32_32x32x4_2b_bf16 v[84:115], v[24:25], v[16:17], 4.0 cbsz:1 abid:1
    v_exp_f32 v128, v128
    v_exp_f32 v129, v129
    v_exp_f32 v130, v130
    v_exp_f32 v131, v131
    v_exp_f32 v132, v132
    v_exp_f32 v133, v133
    v_exp_f32 v134, v134
    v_exp_f32 v135, v135
    v_smfmac_f32_32x32x32_bf16 v[52:67], v[44:47], v[116:123], v1
    v_exp_f32 v136, v136
    v_exp_f32 v137, v137
    v_exp_f32 v138, v138
    v_smfmac_f32_32x32x32_bf16 v[52:67], v[48:51], v[124:131], v1
    v_exp_f32 v139, v139
    v_exp_f32 v140, v140
    v_exp_f32 v141, v141
    v_mfma_f32_32x32x16_bf16 v[84:99], v[20:23], v[8:11], v[84:99]
    v_exp_f32 v142, v142
    v_exp_f32 v143, v143
    v_exp_f32 v144, v144
    v_smfmac_f32_32x32x32_bf16 v[68:83], v[44:47], v[132:139], v1
    v_exp_f32 v145, v145
    v_exp_f32 v146, v146
    v_exp_f32 v147, v147
    v_mfma_f32_32x32x16_bf16 v[100:115], v[20:23], v[12:15], v[100:115]
    v_exp_f32 v84, v84
    v_exp_f32 v85, v85
    v_exp_f32 v86, v86
    v_smfmac_f32_32x32x32_bf16 v[68:83], v[48:51], v[140:147], v1
    v_exp_f32 v87, v87
    v_exp_f32 v88, v88
    v_exp_f32 v89, v89
    s_waitcnt lgkmcnt(0)
    s_setprio 2
    ds_read_b64 v[20:21], v2 offset:35840
    ds_read_b64 v[22:23], v2 offset:35848
    ds_read_b64 v[24:25], v26 offset:35856
    ds_read_b64_tr_b16 v[44:45], v157 offset:0
    ds_read_b64_tr_b16 v[46:47], v157 offset:160
    ds_read_b64_tr_b16 v[48:49], v157 offset:640
    ds_read_b64_tr_b16 v[50:51], v157 offset:800
    v_exp_f32 v90, v90
    v_exp_f32 v91, v91
    v_exp_f32 v92, v92
    v_exp_f32 v93, v93
    v_exp_f32 v94, v94
    v_exp_f32 v95, v95
    v_mfma_f32_32x32x4_2b_bf16 v[116:147], v[32:33], v[16:17], 4.0 cbsz:1 abid:1
    v_exp_f32 v96, v96
    v_exp_f32 v97, v97
    v_exp_f32 v98, v98
    v_exp_f32 v99, v99
    v_exp_f32 v100, v100
    v_exp_f32 v101, v101
    v_exp_f32 v102, v102
    v_exp_f32 v103, v103
    v_smfmac_f32_32x32x32_bf16 v[52:67], v[36:39], v[84:91], v1
    v_exp_f32 v104, v104
    v_exp_f32 v105, v105
    v_exp_f32 v106, v106
    v_smfmac_f32_32x32x32_bf16 v[52:67], v[40:43], v[92:99], v1
    v_exp_f32 v107, v107
    v_exp_f32 v108, v108
    v_exp_f32 v109, v109
    v_mfma_f32_32x32x16_bf16 v[116:131], v[28:31], v[8:11], v[116:131]
    v_exp_f32 v110, v110
    v_exp_f32 v111, v111
    v_exp_f32 v112, v112
    v_smfmac_f32_32x32x32_bf16 v[68:83], v[36:39], v[100:107], v1
    v_exp_f32 v113, v113
    v_exp_f32 v114, v114
    v_exp_f32 v115, v115
    v_mfma_f32_32x32x16_bf16 v[132:147], v[28:31], v[12:15], v[132:147]
    v_exp_f32 v116, v116
    v_exp_f32 v117, v117
    v_exp_f32 v118, v118
    v_smfmac_f32_32x32x32_bf16 v[68:83], v[40:43], v[108:115], v1
    v_exp_f32 v119, v119
    v_exp_f32 v120, v120
    v_exp_f32 v121, v121
    s_waitcnt lgkmcnt(0)
    ds_read_b64 v[28:29], v2 offset:37120
    ds_read_b64 v[30:31], v2 offset:37128
    ds_read_b64 v[32:33], v26 offset:37136
    ds_read_b64_tr_b16 v[36:37], v157 offset:1280
    ds_read_b64_tr_b16 v[38:39], v157 offset:1440
    ds_read_b64_tr_b16 v[40:41], v157 offset:1920
    ds_read_b64_tr_b16 v[42:43], v157 offset:2080
    v_exp_f32 v122, v122
    v_exp_f32 v123, v123
    v_exp_f32 v124, v124
    v_exp_f32 v125, v125
    v_exp_f32 v126, v126
    v_exp_f32 v127, v127
    v_mfma_f32_32x32x4_2b_bf16 v[84:115], v[24:25], v[16:17], 4.0 cbsz:1 abid:1
    v_exp_f32 v128, v128
    v_exp_f32 v129, v129
    v_exp_f32 v130, v130
    v_exp_f32 v131, v131
    v_exp_f32 v132, v132
    v_exp_f32 v133, v133
    v_exp_f32 v134, v134
    v_exp_f32 v135, v135
    v_smfmac_f32_32x32x32_bf16 v[52:67], v[44:47], v[116:123], v1
    v_exp_f32 v136, v136
    v_exp_f32 v137, v137
    v_exp_f32 v138, v138
    v_smfmac_f32_32x32x32_bf16 v[52:67], v[48:51], v[124:131], v1
    v_exp_f32 v139, v139
    v_exp_f32 v140, v140
    v_exp_f32 v141, v141
    v_mfma_f32_32x32x16_bf16 v[84:99], v[20:23], v[8:11], v[84:99]
    v_exp_f32 v142, v142
    v_exp_f32 v143, v143
    v_exp_f32 v144, v144
    v_smfmac_f32_32x32x32_bf16 v[68:83], v[44:47], v[132:139], v1
    v_exp_f32 v145, v145
    v_exp_f32 v146, v146
    v_exp_f32 v147, v147
    v_mfma_f32_32x32x16_bf16 v[100:115], v[20:23], v[12:15], v[100:115]
    v_exp_f32 v84, v84
    v_exp_f32 v85, v85
    v_exp_f32 v86, v86
    v_smfmac_f32_32x32x32_bf16 v[68:83], v[48:51], v[140:147], v1
    v_exp_f32 v87, v87
    v_exp_f32 v88, v88
    v_exp_f32 v89, v89
    s_waitcnt lgkmcnt(0)
    ds_read_b64 v[20:21], v2 offset:38400
    ds_read_b64 v[22:23], v2 offset:38408
    ds_read_b64 v[24:25], v27 offset:38400
    ds_read_b64_tr_b16 v[44:45], v157 offset:2560
    ds_read_b64_tr_b16 v[46:47], v157 offset:2720
    ds_read_b64_tr_b16 v[48:49], v157 offset:3200
    ds_read_b64_tr_b16 v[50:51], v157 offset:3360
    v_exp_f32 v90, v90
    v_exp_f32 v91, v91
    v_exp_f32 v92, v92
    v_exp_f32 v93, v93
    v_exp_f32 v94, v94
    v_exp_f32 v95, v95
    v_mfma_f32_32x32x4_2b_bf16 v[116:147], v[32:33], v[16:17], 4.0 cbsz:1 abid:1
    v_exp_f32 v96, v96
    v_exp_f32 v97, v97
    v_exp_f32 v98, v98
    v_exp_f32 v99, v99
    v_exp_f32 v100, v100
    v_exp_f32 v101, v101
    v_exp_f32 v102, v102
    v_exp_f32 v103, v103
    v_smfmac_f32_32x32x32_bf16 v[52:67], v[36:39], v[84:91], v1
    v_exp_f32 v104, v104
    v_exp_f32 v105, v105
    v_exp_f32 v106, v106
    v_smfmac_f32_32x32x32_bf16 v[52:67], v[40:43], v[92:99], v1
    v_exp_f32 v107, v107
    v_exp_f32 v108, v108
    v_exp_f32 v109, v109
    v_mfma_f32_32x32x16_bf16 v[116:131], v[28:31], v[8:11], v[116:131]
    v_exp_f32 v110, v110
    v_exp_f32 v111, v111
    v_exp_f32 v112, v112
    v_smfmac_f32_32x32x32_bf16 v[68:83], v[36:39], v[100:107], v1
    v_exp_f32 v113, v113
    v_exp_f32 v114, v114
    v_exp_f32 v115, v115
    v_mfma_f32_32x32x16_bf16 v[132:147], v[28:31], v[12:15], v[132:147]
    v_exp_f32 v116, v116
    v_exp_f32 v117, v117
    v_exp_f32 v118, v118
    v_smfmac_f32_32x32x32_bf16 v[68:83], v[40:43], v[108:115], v1
    v_exp_f32 v119, v119
    v_exp_f32 v120, v120
    v_exp_f32 v121, v121
    s_waitcnt lgkmcnt(0)
    ds_read_b64 v[28:29], v2 offset:39680
    ds_read_b64 v[30:31], v2 offset:39688
    ds_read_b64 v[32:33], v35 offset:38400
    ds_read_b64_tr_b16 v[36:37], v158 offset:0
    ds_read_b64_tr_b16 v[38:39], v158 offset:160
    ds_read_b64_tr_b16 v[40:41], v158 offset:640
    ds_read_b64_tr_b16 v[42:43], v158 offset:800
    v_exp_f32 v122, v122
    v_exp_f32 v123, v123
    v_exp_f32 v124, v124
    v_exp_f32 v125, v125
    v_exp_f32 v126, v126
    v_exp_f32 v127, v127
    v_mfma_f32_32x32x4_2b_bf16 v[84:115], v[24:25], v[16:17], 4.0 blgp:2
    v_exp_f32 v128, v128
    v_exp_f32 v129, v129
    v_exp_f32 v130, v130
    v_exp_f32 v131, v131
    v_exp_f32 v132, v132
    v_exp_f32 v133, v133
    v_exp_f32 v134, v134
    v_exp_f32 v135, v135
    v_smfmac_f32_32x32x32_bf16 v[52:67], v[44:47], v[116:123], v1
    v_exp_f32 v136, v136
    v_exp_f32 v137, v137
    v_exp_f32 v138, v138
    v_smfmac_f32_32x32x32_bf16 v[52:67], v[48:51], v[124:131], v1
    v_exp_f32 v139, v139
    v_exp_f32 v140, v140
    v_exp_f32 v141, v141
    v_mfma_f32_32x32x16_bf16 v[84:99], v[20:23], v[12:15], v[84:99]
    v_exp_f32 v142, v142
    v_exp_f32 v143, v143
    v_exp_f32 v144, v144
    v_smfmac_f32_32x32x32_bf16 v[68:83], v[44:47], v[132:139], v1
    v_exp_f32 v145, v145
    v_exp_f32 v146, v146
    v_exp_f32 v147, v147
    v_add_u32 v3, s38, v6
    ds_write_b128 v3, v[52:55] offset:0
    ds_write_b128 v3, v[56:59] offset:1024
    ds_write_b128 v3, v[60:63] offset:2048
    s_waitcnt lgkmcnt(3)
    s_setprio 1
    v_mfma_f32_32x32x16_bf16 v[100:115], v[28:31], v[12:15], v[100:115]
    v_exp_f32 v84, v84
    v_exp_f32 v85, v85
    v_exp_f32 v86, v86
    v_smfmac_f32_32x32x32_bf16 v[68:83], v[48:51], v[140:147], v1
    v_exp_f32 v87, v87
    v_exp_f32 v88, v88
    v_exp_f32 v89, v89
    ds_read_b64 v[20:21], v34 offset:38400
    ds_read_b64 v[22:23], v34 offset:38408
    ds_read_b64_tr_b16 v[44:45], v158 offset:1280
    ds_read_b64_tr_b16 v[46:47], v158 offset:1440
    ds_read_b64_tr_b16 v[48:49], v158 offset:1920
    ds_read_b64_tr_b16 v[50:51], v158 offset:2080
    ds_read_b64 v[28:29], v34 offset:39680
    ds_read_b64 v[30:31], v34 offset:39688
    v_exp_f32 v90, v90
    v_exp_f32 v91, v91
    v_exp_f32 v92, v92
    v_exp_f32 v93, v93
    v_exp_f32 v94, v94
    v_exp_f32 v95, v95
    v_mfma_f32_32x32x4_2b_bf16 v[116:147], v[32:33], v[16:17], 4.0 blgp:2
    v_exp_f32 v96, v96
    v_exp_f32 v97, v97
    v_exp_f32 v98, v98
    v_exp_f32 v99, v99
    v_exp_f32 v100, v100
    v_exp_f32 v101, v101
    v_exp_f32 v102, v102
    v_exp_f32 v103, v103
    v_smfmac_f32_32x32x32_bf16 v[68:83], v[36:39], v[84:91], v1
    v_exp_f32 v104, v104
    v_exp_f32 v105, v105
    v_exp_f32 v106, v106
    v_smfmac_f32_32x32x32_bf16 v[68:83], v[40:43], v[92:99], v1
    v_exp_f32 v107, v107
    v_exp_f32 v108, v108
    v_exp_f32 v109, v109
    s_waitcnt lgkmcnt(0)
    ds_read_b64_tr_b16 v[36:37], v18 offset:0
    ds_read_b64_tr_b16 v[38:39], v18 offset:160
    ds_read_b64_tr_b16 v[40:41], v18 offset:640
    ds_read_b64_tr_b16 v[42:43], v18 offset:800
    v_mfma_f32_32x32x16_bf16 v[116:131], v[20:23], v[12:15], v[116:131]
    s_cbranch_scc0 L_x1
    s_barrier
L_x1:
    v_exp_f32 v110, v110
    v_exp_f32 v111, v111
    v_exp_f32 v112, v112
    v_smfmac_f32_32x32x32_bf16 v[68:83], v[44:47], v[100:107], v1
    v_exp_f32 v113, v113
    v_exp_f32 v114, v114
    v_exp_f32 v115, v115
    v_add_u32 v4, s39, v6
    s_setprio 0
    v_mfma_f32_32x32x16_bf16 v[132:147], v[28:31], v[12:15], v[132:147]
    v_exp_f32 v116, v116
    v_exp_f32 v117, v117
    v_exp_f32 v118, v118
    v_smfmac_f32_32x32x32_bf16 v[68:83], v[48:51], v[108:115], v1
    v_exp_f32 v119, v119
    v_exp_f32 v120, v120
    v_exp_f32 v121, v121
    ds_read_b64_tr_b16 v[44:45], v18 offset:1280
    ds_read_b64_tr_b16 v[46:47], v18 offset:1440
    ds_read_b64_tr_b16 v[48:49], v18 offset:1920
    ds_read_b64_tr_b16 v[50:51], v18 offset:2080
    v_exp_f32 v122, v122
    v_exp_f32 v123, v123
    v_exp_f32 v124, v124
    v_exp_f32 v125, v125
    s_waitcnt lgkmcnt(4)
    v_smfmac_f32_32x32x32_bf16 v[68:83], v[36:39], v[116:123], v1
    v_exp_f32 v126, v126
    v_exp_f32 v127, v127
    v_exp_f32 v128, v128
    v_exp_f32 v129, v129
    v_exp_f32 v130, v130
    v_exp_f32 v131, v131
    v_exp_f32 v132, v132
    v_exp_f32 v133, v133
    s_cbranch_scc1 L_x2
    s_barrier
L_x2:
    ds_read_b128 v[60:63], v4 offset:2048
    ds_read_b128 v[52:55], v4 offset:0
    ds_read_b128 v[56:59], v4 offset:1024
    v_smfmac_f32_32x32x32_bf16 v[68:83], v[40:43], v[124:131], v1
    v_exp_f32 v134, v134
    v_exp_f32 v135, v135
    v_exp_f32 v136, v136
    v_exp_f32 v137, v137
    v_exp_f32 v138, v138
    v_exp_f32 v139, v139
    v_exp_f32 v140, v140
    v_exp_f32 v141, v141
    s_waitcnt lgkmcnt(3)
    v_smfmac_f32_32x32x32_bf16 v[68:83], v[44:47], v[132:139], v1
    v_exp_f32 v142, v142
    v_exp_f32 v143, v143
    v_exp_f32 v144, v144
    v_exp_f32 v145, v145
    v_exp_f32 v146, v146
    v_exp_f32 v147, v147
    s_nop 1
    v_smfmac_f32_32x32x32_bf16 v[68:83], v[48:51], v[140:147], v1
    v_add_u32 v3, s39, v7
    s_nop 9
    s_waitcnt lgkmcnt(0)
    v_add_f32 v65, v76, v60
    v_add_f32 v64, v76, v60
    v_pk_add_f32 v[52:53], v[68:69], v[52:53]
    v_pk_add_f32 v[54:55], v[70:71], v[54:55]
L_norm:
    v_permlane32_swap_b32 v65, v64
    v_pk_add_f32 v[56:57], v[72:73], v[56:57]
    v_pk_add_f32 v[58:59], v[74:75], v[58:59]
    v_rcp_f32 v66, v64
    v_pk_add_f32 v[60:61], v[76:77], v[60:61]
    v_pk_add_f32 v[62:63], v[78:79], v[62:63]
    v_pk_mul_f32 v[52:53], v[52:53], v[66:67] op_sel_hi:[1,0]
    v_pk_mul_f32 v[54:55], v[54:55], v[66:67] op_sel_hi:[1,0]
    v_pk_mul_f32 v[56:57], v[56:57], v[66:67] op_sel_hi:[1,0]
    v_pk_mul_f32 v[58:59], v[58:59], v[66:67] op_sel_hi:[1,0]
    v_cvt_pk_bf16_f32 v100, v52, v53
    v_cvt_pk_bf16_f32 v101, v54, v55
    v_cvt_pk_bf16_f32 v102, v56, v57
    v_cvt_pk_bf16_f32 v103, v58, v59
    ds_write2_b64 v3, v[100:101], v[102:103] offset0:0 offset1:1
    v_pk_mul_f32 v[60:61], v[60:61], v[66:67] op_sel_hi:[1,0]
    v_pk_mul_f32 v[62:63], v[62:63], v[66:67] op_sel_hi:[1,0]
    v_cvt_pk_bf16_f32 v104, v60, v61
    v_cvt_pk_bf16_f32 v105, v62, v63
    s_mov_b32 exec_hi, 0
    ds_write_b64 v3, v[104:105] offset:32
    s_mov_b64 exec, -1
    ds_read_b128 v[108:111], v4
    ds_read_b128 v[112:115], v4 offset:1024
    s_waitcnt lgkmcnt(1)
    buffer_store_dwordx4 v[108:111], v6, s[20:23], s27 offen sc1
    s_mov_b64 exec, 0xffff
    s_waitcnt lgkmcnt(0)
    buffer_store_dwordx4 v[112:115], v6, s[20:23], s27 offen offset:1024 sc1
    s_mov_b64 exec, -1
    v_pk_add_f32 v[52:53], v[52:53], v[54:55]
    v_pk_add_f32 v[56:57], v[56:57], v[58:59]
    v_pk_add_f32 v[60:61], v[60:61], v[62:63]
    v_cmp_nle_f32 vcc, 1.0, v64
    v_pk_add_f32 v[52:53], v[52:53], v[56:57]
    s_mov_b32 s5, 0x71800000
    v_pk_add_f32 v[52:53], v[52:53], v[60:61]
    v_cmp_ngt_f32 s[6:7], s5, v64
    v_add_f32 v52, v52, v53
    s_or_b64 s[6:7], s[6:7], vcc
    s_movk_i32 s5, 0x207
    v_cmp_class_f32 vcc, v52, s5
    s_or_b64 s[6:7], s[6:7], vcc
    s_cbranch_scc1 L_fallback
L_done:
L_end:
    s_endpgm
L_loader:
    v_mov_b32 v84, 0x3f80
    v_mov_b32 v85, 0
    v_mov_b32 v86, 0x3f80
    v_mov_b32 v87, 0
    ds_write_b128 v6, v[84:87] offset:0
    ds_write_b128 v6, v[84:87] offset:1024
    ds_write_b128 v6, v[84:87] offset:2048
    ds_write_b128 v6, v[84:87] offset:3072
    s_waitcnt lgkmcnt(0)
    s_barrier
    s_mov_b32 m0, 92160
    s_add_u32 s5, s3, 8192
    buffer_load_dwordx4 v6, s[12:15], s5 offen offset:0 lds
    buffer_load_dwordx4 v6, s[12:15], s5 offen offset:1024 lds
    buffer_load_dwordx4 v6, s[12:15], s5 offen offset:2048 lds
    buffer_load_dwordx4 v6, s[12:15], s5 offen offset:3072 lds
    s_mov_b32 m0, 12288
    s_add_u32 s5, s3, 8192
    buffer_load_dwordx4 v6, s[16:19], s5 offen offset:0 lds
    buffer_load_dwordx4 v6, s[16:19], s5 offen offset:1024 lds
    buffer_load_dwordx4 v6, s[16:19], s5 offen offset:2048 lds
    buffer_load_dwordx4 v6, s[16:19], s5 offen offset:3072 lds
    s_mov_b32 m0, 126976
    s_add_u32 s5, s3, 45056
    buffer_load_dwordx4 v6, s[12:15], s5 offen offset:0 lds
    buffer_load_dwordx4 v6, s[12:15], s5 offen offset:1024 lds
    buffer_load_dwordx4 v6, s[12:15], s5 offen offset:2048 lds
    buffer_load_dwordx4 v6, s[12:15], s5 offen offset:3072 lds
    s_mov_b32 m0, 49152
    s_add_u32 s5, s3, 45056
    buffer_load_dwordx4 v6, s[16:19], s5 offen offset:0 lds
    buffer_load_dwordx4 v6, s[16:19], s5 offen offset:1024 lds
    buffer_load_dwordx4 v6, s[16:19], s5 offen offset:2048 lds
    buffer_load_dwordx4 v6, s[16:19], s5 offen offset:3072 lds
    s_mov_b32 m0, 96256
    s_add_u32 s5, s3, 12288
    buffer_load_dwordx4 v6, s[12:15], s5 offen offset:0 lds
    buffer_load_dwordx4 v6, s[12:15], s5 offen offset:1024 lds
    buffer_load_dwordx4 v6, s[12:15], s5 offen offset:2048 lds
    buffer_load_dwordx4 v6, s[12:15], s5 offen offset:3072 lds
    s_mov_b32 m0, 16384
    s_add_u32 s5, s3, 12288
    buffer_load_dwordx4 v6, s[16:19], s5 offen offset:0 lds
    buffer_load_dwordx4 v6, s[16:19], s5 offen offset:1024 lds
    buffer_load_dwordx4 v6, s[16:19], s5 offen offset:2048 lds
    buffer_load_dwordx4 v6, s[16:19], s5 offen offset:3072 lds
    s_mov_b32 m0, 100352
    s_add_u32 s5, s3, 16384
    buffer_load_dwordx4 v6, s[12:15], s5 offen offset:0 lds
    buffer_load_dwordx4 v6, s[12:15], s5 offen offset:1024 lds
    buffer_load_dwordx4 v6, s[12:15], s5 offen offset:2048 lds
    buffer_load_dwordx4 v6, s[12:15], s5 offen offset:3072 lds
    s_mov_b32 m0, 20480
    s_add_u32 s5, s3, 16384
    buffer_load_dwordx4 v6, s[16:19], s5 offen offset:0 lds
    buffer_load_dwordx4 v6, s[16:19], s5 offen offset:1024 lds
    buffer_load_dwordx4 v6, s[16:19], s5 offen offset:2048 lds
    buffer_load_dwordx4 v6, s[16:19], s5 offen offset:3072 lds
    s_mov_b32 m0, 104448
    s_add_u32 s5, s3, 20480
    buffer_load_dwordx4 v6, s[12:15], s5 offen offset:0 lds
    buffer_load_dwordx4 v6, s[12:15], s5 offen offset:1024 lds
    buffer_load_dwordx4 v6, s[12:15], s5 offen offset:2048 lds
    buffer_load_dwordx4 v6, s[12:15], s5 offen offset:3072 lds
    s_mov_b32 m0, 24576
    s_add_u32 s5, s3, 20480
    buffer_load_dwordx4 v6, s[16:19], s5 offen offset:0 lds
    buffer_load_dwordx4 v6, s[16:19], s5 offen offset:1024 lds
    buffer_load_dwordx4 v6, s[16:19], s5 offen offset:2048 lds
    buffer_load_dwordx4 v6, s[16:19], s5 offen offset:3072 lds
    s_mov_b32 m0, 131072
    s_add_u32 s5, s3, 49152
    buffer_load_dwordx4 v6, s[12:15], s5 offen offset:0 lds
    buffer_load_dwordx4 v6, s[12:15], s5 offen offset:1024 lds
    buffer_load_dwordx4 v6, s[12:15], s5 offen offset:2048 lds
    buffer_load_dwordx4 v6, s[12:15], s5 offen offset:3072 lds
    s_mov_b32 m0, 53248
    s_add_u32 s5, s3, 49152
    buffer_load_dwordx4 v6, s[16:19], s5 offen offset:0 lds
    buffer_load_dwordx4 v6, s[16:19], s5 offen offset:1024 lds
    buffer_load_dwordx4 v6, s[16:19], s5 offen offset:2048 lds
    buffer_load_dwordx4 v6, s[16:19], s5 offen offset:3072 lds
    s_waitcnt vmcnt(16)
    s_barrier
    s_mov_b32 m0, 108544
    s_add_u32 s5, s3, 24576
    buffer_load_dwordx4 v6, s[12:15], s5 offen offset:0 lds
    buffer_load_dwordx4 v6, s[12:15], s5 offen offset:1024 lds
    buffer_load_dwordx4 v6, s[12:15], s5 offen offset:2048 lds
    buffer_load_dwordx4 v6, s[12:15], s5 offen offset:3072 lds
    s_mov_b32 m0, 28672
    s_add_u32 s5, s3, 24576
    buffer_load_dwordx4 v6, s[16:19], s5 offen offset:0 lds
    buffer_load_dwordx4 v6, s[16:19], s5 offen offset:1024 lds
    buffer_load_dwordx4 v6, s[16:19], s5 offen offset:2048 lds
    buffer_load_dwordx4 v6, s[16:19], s5 offen offset:3072 lds
    s_mov_b32 m0, 135168
    s_add_u32 s5, s3, 53248
    buffer_load_dwordx4 v6, s[12:15], s5 offen offset:0 lds
    buffer_load_dwordx4 v6, s[12:15], s5 offen offset:1024 lds
    buffer_load_dwordx4 v6, s[12:15], s5 offen offset:2048 lds
    buffer_load_dwordx4 v6, s[12:15], s5 offen offset:3072 lds
    s_mov_b32 m0, 57344
    s_add_u32 s5, s3, 53248
    buffer_load_dwordx4 v6, s[16:19], s5 offen offset:0 lds
    buffer_load_dwordx4 v6, s[16:19], s5 offen offset:1024 lds
    buffer_load_dwordx4 v6, s[16:19], s5 offen offset:2048 lds
    buffer_load_dwordx4 v6, s[16:19], s5 offen offset:3072 lds
    s_mov_b32 m0, 112640
    s_add_u32 s5, s3, 28672
    buffer_load_dwordx4 v6, s[12:15], s5 offen offset:0 lds
    buffer_load_dwordx4 v6, s[12:15], s5 offen offset:1024 lds
    buffer_load_dwordx4 v6, s[12:15], s5 offen offset:2048 lds
    buffer_load_dwordx4 v6, s[12:15], s5 offen offset:3072 lds
    s_mov_b32 m0, 32768
    s_add_u32 s5, s3, 28672
    buffer_load_dwordx4 v6, s[16:19], s5 offen offset:0 lds
    buffer_load_dwordx4 v6, s[16:19], s5 offen offset:1024 lds
    buffer_load_dwordx4 v6, s[16:19], s5 offen offset:2048 lds
    buffer_load_dwordx4 v6, s[16:19], s5 offen offset:3072 lds
    s_mov_b32 m0, 139264
    s_add_u32 s5, s3, 57344
    buffer_load_dwordx4 v6, s[12:15], s5 offen offset:0 lds
    buffer_load_dwordx4 v6, s[12:15], s5 offen offset:1024 lds
    buffer_load_dwordx4 v6, s[12:15], s5 offen offset:2048 lds
    buffer_load_dwordx4 v6, s[12:15], s5 offen offset:3072 lds
    s_mov_b32 m0, 61440
    s_add_u32 s5, s3, 57344
    buffer_load_dwordx4 v6, s[16:19], s5 offen offset:0 lds
    buffer_load_dwordx4 v6, s[16:19], s5 offen offset:1024 lds
    buffer_load_dwordx4 v6, s[16:19], s5 offen offset:2048 lds
    buffer_load_dwordx4 v6, s[16:19], s5 offen offset:3072 lds
    s_mov_b32 m0, 116736
    s_add_u32 s5, s3, 32768
    buffer_load_dwordx4 v6, s[12:15], s5 offen offset:0 lds
    buffer_load_dwordx4 v6, s[12:15], s5 offen offset:1024 lds
    buffer_load_dwordx4 v6, s[12:15], s5 offen offset:2048 lds
    buffer_load_dwordx4 v6, s[12:15], s5 offen offset:3072 lds
    s_mov_b32 m0, 36864
    s_add_u32 s5, s3, 32768
    buffer_load_dwordx4 v6, s[16:19], s5 offen offset:0 lds
    buffer_load_dwordx4 v6, s[16:19], s5 offen offset:1024 lds
    buffer_load_dwordx4 v6, s[16:19], s5 offen offset:2048 lds
    buffer_load_dwordx4 v6, s[16:19], s5 offen offset:3072 lds
    s_mov_b32 m0, 143360
    s_add_u32 s5, s3, 61440
    buffer_load_dwordx4 v6, s[12:15], s5 offen offset:0 lds
    buffer_load_dwordx4 v6, s[12:15], s5 offen offset:1024 lds
    buffer_load_dwordx4 v6, s[12:15], s5 offen offset:2048 lds
    buffer_load_dwordx4 v6, s[12:15], s5 offen offset:3072 lds
    s_mov_b32 m0, 65536
    s_add_u32 s5, s3, 61440
    buffer_load_dwordx4 v6, s[16:19], s5 offen offset:0 lds
    buffer_load_dwordx4 v6, s[16:19], s5 offen offset:1024 lds
    buffer_load_dwordx4 v6, s[16:19], s5 offen offset:2048 lds
    buffer_load_dwordx4 v6, s[16:19], s5 offen offset:3072 lds
    s_mov_b32 m0, 120832
    s_add_u32 s5, s3, 36864
    buffer_load_dwordx4 v6, s[12:15], s5 offen offset:0 lds
    buffer_load_dwordx4 v6, s[12:15], s5 offen offset:1024 lds
    s_mov_b32 m0, 40960
    s_add_u32 s5, s3, 36864
    buffer_load_dwordx4 v6, s[16:19], s5 offen offset:0 lds
    buffer_load_dwordx4 v6, s[16:19], s5 offen offset:1024 lds
    buffer_load_dwordx4 v6, s[16:19], s5 offen offset:2048 lds
    buffer_load_dwordx4 v6, s[16:19], s5 offen offset:3072 lds
    s_mov_b32 m0, 147456
    s_add_u32 s5, s3, 65536
    buffer_load_dwordx4 v6, s[12:15], s5 offen offset:0 lds
    buffer_load_dwordx4 v6, s[12:15], s5 offen offset:1024 lds
    buffer_load_dwordx4 v6, s[12:15], s5 offen offset:2048 lds
    buffer_load_dwordx4 v6, s[12:15], s5 offen offset:3072 lds
    s_mov_b32 m0, 69632
    s_add_u32 s5, s3, 65536
    buffer_load_dwordx4 v6, s[16:19], s5 offen offset:0 lds
    buffer_load_dwordx4 v6, s[16:19], s5 offen offset:1024 lds
    buffer_load_dwordx4 v6, s[16:19], s5 offen offset:2048 lds
    buffer_load_dwordx4 v6, s[16:19], s5 offen offset:3072 lds
    s_mov_b32 m0, 151552
    s_add_u32 s5, s3, 69632
    buffer_load_dwordx4 v6, s[12:15], s5 offen offset:0 lds
    buffer_load_dwordx4 v6, s[12:15], s5 offen offset:1024 lds
    buffer_load_dwordx4 v6, s[12:15], s5 offen offset:2048 lds
    buffer_load_dwordx4 v6, s[12:15], s5 offen offset:3072 lds
    s_mov_b32 m0, 155648
    s_add_u32 s5, s3, 73728
    buffer_load_dwordx4 v6, s[12:15], s5 offen offset:0 lds
    buffer_load_dwordx4 v6, s[12:15], s5 offen offset:1024 lds
    buffer_load_dwordx4 v6, s[12:15], s5 offen offset:2048 lds
    buffer_load_dwordx4 v6, s[12:15], s5 offen offset:3072 lds
    s_mov_b32 m0, 159744
    s_add_u32 s5, s3, 77824
    buffer_load_dwordx4 v6, s[12:15], s5 offen offset:0 lds
    buffer_load_dwordx4 v6, s[12:15], s5 offen offset:1024 lds
    buffer_load_dwordx4 v6, s[12:15], s5 offen offset:2048 lds
    buffer_load_dwordx4 v6, s[12:15], s5 offen offset:3072 lds
    s_mov_b32 m0, 122880
    s_add_u32 s5, s3, 38912
    buffer_load_dwordx4 v6, s[12:15], s5 offen offset:0 lds
    buffer_load_dwordx4 v6, s[12:15], s5 offen offset:1024 lds
    s_mov_b32 m0, 73728
    s_add_u32 s5, s3, 69632
    buffer_load_dwordx4 v6, s[16:19], s5 offen offset:0 lds
    buffer_load_dwordx4 v6, s[16:19], s5 offen offset:1024 lds
    buffer_load_dwordx4 v6, s[16:19], s5 offen offset:2048 lds
    buffer_load_dwordx4 v6, s[16:19], s5 offen offset:3072 lds
    s_mov_b32 m0, 77824
    s_add_u32 s5, s3, 73728
    buffer_load_dwordx4 v6, s[16:19], s5 offen offset:0 lds
    buffer_load_dwordx4 v6, s[16:19], s5 offen offset:1024 lds
    buffer_load_dwordx4 v6, s[16:19], s5 offen offset:2048 lds
    buffer_load_dwordx4 v6, s[16:19], s5 offen offset:3072 lds
    s_mov_b32 m0, 81920
    s_add_u32 s5, s3, 77824
    buffer_load_dwordx4 v6, s[16:19], s5 offen offset:0 lds
    buffer_load_dwordx4 v6, s[16:19], s5 offen offset:1024 lds
    buffer_load_dwordx4 v6, s[16:19], s5 offen offset:2048 lds
    buffer_load_dwordx4 v6, s[16:19], s5 offen offset:3072 lds
    s_waitcnt vmcnt(0)
    s_barrier
    s_endpgm
L_fallback:
    s_cmp_lg_u32 s34, 0
    s_cbranch_scc1 L_done
    s_mov_b32 s34, 1
    s_lshl_b32 s5, s24, 11
    s_add_u32 s5, s5, 124928
    s_mov_b32 m0, s5
    s_mul_i32 s6, s26, 40960
    s_sub_u32 s5, s5, s6
    s_sub_u32 s5, s5, 4096
    v_and_b32 v58, 19, v0
    v_cmp_lt_u32 vcc, 16, v58
    v_add_u32 v55, s5, v148
    s_nop 0
    v_cndmask_b32 v55, v55, v148, vcc
    v_cmp_lt_u32 vcc, 31, v0
    s_nop 1
    v_cndmask_b32 v56, 0, v16, vcc
    v_cndmask_b32 v57, 0, v17, vcc
    v_mov_b32 v52, 0xff7fffff
    v_mov_b64 v[68:69], 0
    v_mov_b64 v[70:71], 0
    v_mov_b64 v[72:73], 0
    v_mov_b64 v[74:75], 0
    v_mov_b64 v[76:77], 0
    v_mov_b64 v[78:79], 0
    v_mov_b64 v[80:81], 0
    v_mov_b64 v[82:83], 0
    s_mov_b32 s5, s3
    s_add_u32 s6, s3, 81920
L_fb:
    buffer_load_dwordx4 v[20:23], v7, s[12:15], s5 offen
    buffer_load_dwordx2 v[24:25], v7, s[12:15], s5 offen offset:16
    buffer_load_dwordx4 v6, s[16:19], s5 offen lds
    s_mov_b64 exec, 0xffff
    buffer_load_dwordx4 v6, s[16:19], s5 offen offset:1024 lds
    s_mov_b64 exec, -1
    s_waitcnt vmcnt(0)
    ds_read_b64_tr_b16 v[36:37], v55 offset:0
    ds_read_b64_tr_b16 v[38:39], v55 offset:160
    ds_read_b64_tr_b16 v[40:41], v55 offset:640
    ds_read_b64_tr_b16 v[42:43], v55 offset:800
    v_mfma_f32_32x32x8_bf16 v[116:131], v[24:25], v[56:57], 0
    s_nop 11
    v_mfma_f32_32x32x16_bf16 v[116:131], v[20:23], v[12:15], v[116:131]
    s_nop 15
    v_max3_f32 v53, v116, v117, v52
    v_max3_f32 v53, v118, v119, v53
    v_max3_f32 v53, v120, v121, v53
    v_max3_f32 v53, v122, v123, v53
    v_max3_f32 v53, v124, v125, v53
    v_max3_f32 v53, v126, v127, v53
    v_max3_f32 v53, v128, v129, v53
    v_max3_f32 v53, v130, v131, v53
    v_mov_b32 v58, v53
    s_nop 1
    v_permlane32_swap_b32 v58, v53
    s_nop 1
    v_max_f32 v53, v53, v58
    v_sub_f32 v54, v52, v53
    v_exp_f32 v54, v54
    v_mov_b32 v52, v53
    v_sub_f32 v116, v116, v53
    v_sub_f32 v117, v117, v53
    v_sub_f32 v118, v118, v53
    v_sub_f32 v119, v119, v53
    v_sub_f32 v120, v120, v53
    v_sub_f32 v121, v121, v53
    v_sub_f32 v122, v122, v53
    v_sub_f32 v123, v123, v53
    v_sub_f32 v124, v124, v53
    v_sub_f32 v125, v125, v53
    v_sub_f32 v126, v126, v53
    v_sub_f32 v127, v127, v53
    v_sub_f32 v128, v128, v53
    v_sub_f32 v129, v129, v53
    v_sub_f32 v130, v130, v53
    v_sub_f32 v131, v131, v53
    v_exp_f32 v116, v116
    v_exp_f32 v117, v117
    v_exp_f32 v118, v118
    v_exp_f32 v119, v119
    v_exp_f32 v120, v120
    v_exp_f32 v121, v121
    v_exp_f32 v122, v122
    v_exp_f32 v123, v123
    v_exp_f32 v124, v124
    v_exp_f32 v125, v125
    v_exp_f32 v126, v126
    v_exp_f32 v127, v127
    v_exp_f32 v128, v128
    v_exp_f32 v129, v129
    v_exp_f32 v130, v130
    v_exp_f32 v131, v131
    v_mul_f32 v68, v68, v54
    v_mul_f32 v69, v69, v54
    v_mul_f32 v70, v70, v54
    v_mul_f32 v71, v71, v54
    v_mul_f32 v72, v72, v54
    v_mul_f32 v73, v73, v54
    v_mul_f32 v74, v74, v54
    v_mul_f32 v75, v75, v54
    v_mul_f32 v76, v76, v54
    v_mul_f32 v77, v77, v54
    v_mul_f32 v78, v78, v54
    v_mul_f32 v79, v79, v54
    s_waitcnt lgkmcnt(0)
    s_nop 1
    v_smfmac_f32_32x32x32_bf16 v[68:83], v[36:39], v[116:123], v1
    v_smfmac_f32_32x32x32_bf16 v[68:83], v[40:43], v[124:131], v1
    s_addk_i32 s5, 1280
    s_cmp_lt_u32 s5, s6
    s_cbranch_scc1 L_fb
    s_nop 15
    v_mov_b32 v52, v68
    v_mov_b32 v53, v69
    v_mov_b32 v54, v70
    v_mov_b32 v55, v71
    v_mov_b32 v56, 0
    v_mov_b32 v57, 0
    v_mov_b32 v58, 0
    v_mov_b32 v59, 0
    v_mov_b32 v60, 0
    v_mov_b32 v61, 0
    v_mov_b32 v62, 0
    v_mov_b32 v63, 0
    v_mov_b32 v65, v76
    v_mov_b32 v64, v76
    s_nop 1
    s_branch L_norm
L_codeend:
    .if (L_codeend - standalone__fused_io_aware_attn__prompt_kernel) < 11584
    .error "code prefetch would read past the kernel"
    .endif
.section .rodata,"a"
.p2align 6
.amdhsa_kernel standalone__fused_io_aware_attn__prompt_kernel
  .amdhsa_next_free_vgpr 160
  .amdhsa_next_free_sgpr 40
  .amdhsa_accum_offset 160
  .amdhsa_group_segment_fixed_size 0
  .amdhsa_kernarg_size 48
  .amdhsa_user_sgpr_count 2
  .amdhsa_user_sgpr_kernarg_segment_ptr 1
  .amdhsa_system_sgpr_workgroup_id_x 1
.end_amdhsa_kernel
```
